```python
import torch

def _softmax(x, axis=-1):
    return torch.softmax(x, dim=axis)
def _gelu(x):
    return torch.nn.functional.gelu(x, approximate="tanh")
def _silu(x):
    return torch.nn.functional.silu(x)
def _sigmoid(x):
    return torch.sigmoid(x)
def _layernorm(x, axis=-1, eps=1e-5):
    m = x.mean(dim=axis, keepdim=True)
    v = x.var(dim=axis, keepdim=True, unbiased=False)
    return (x - m) / torch.sqrt(v + eps)
def _scatter_add(tgt, idx, src, axis=0):
    return tgt.clone().index_add_(axis, idx, src)
def _segment_sum(src, seg, n):
    out = torch.zeros((n,) + src.shape[1:], dtype=src.dtype)
    return out.index_add_(0, seg, src)
def _pad(x, pw):
    flat = tuple(v for pair in reversed(pw) for v in pair)
    return torch.nn.functional.pad(x, flat)

kernel_name = 'recurrent_scan__gqa_block_cached__glu_gated_bilinear__decode'

def setup_inputs():

    _w = (lambda a: (lambda t: t.to(torch.bfloat16) if t.is_floating_point() else t)(torch.as_tensor(a)))
    def _A_setup():
        B, Sq, D = 8, 1, 448
        Hq, Hkv, Sk, Dh = 16, 8, 8192, 256
        assert Hq % Hkv == 0, (Hq, Hkv)
        return {
            "x": _w((lambda *s: torch.randn(*s, dtype=torch.bfloat16) * 0.4)(B, Sq, D)),
            "k_cache": _w((lambda *s: torch.randn(*s, dtype=torch.bfloat16) * 1.6)(B, Hkv, Sk, Dh)),
            "v_cache": _w((lambda *s: torch.randn(*s, dtype=torch.bfloat16) * 1.6)(B, Hkv, Sk, Dh)),
            "wq": _w((lambda *s: torch.randn(*s, dtype=torch.bfloat16) * 1.6)(D, Hq * Dh) * (D ** -0.5)),
            "wo": _w((lambda *s: torch.randn(*s, dtype=torch.bfloat16) * 1.6)(Hq * Dh, D) * ((Hq * Dh) ** -0.5)),
        }
    _A_in = _A_setup()

    def _B_setup():
        B, S, D, F = 8, 1, 448, 1792
        return {
            "x": _w((lambda *s: torch.randn(*s, dtype=torch.bfloat16) * 0.4)(B, S, D)),
            "w_gate": _w((lambda *s: torch.randn(*s, dtype=torch.bfloat16) * 1.6)(D, F) * (D ** -0.5)),
            "w_up": _w((lambda *s: torch.randn(*s, dtype=torch.bfloat16) * 1.6)(D, F) * (D ** -0.5)),
            "w_down": _w((lambda *s: torch.randn(*s, dtype=torch.bfloat16) * 1.6)(F, D) * (F ** -0.5)),
        }
    _B_in = _B_setup()

    return {
        "A_x": _A_in["x"],
        "A_k_cache": _A_in["k_cache"],
        "A_v_cache": _A_in["v_cache"],
        "A_wq": _A_in["wq"],
        "A_wo": _A_in["wo"],
        "B_x": _B_in["x"],
        "B_w_gate": _B_in["w_gate"],
        "B_w_up": _B_in["w_up"],
        "B_w_down": _B_in["w_down"],
    }

def reference(A_x, A_k_cache, A_v_cache, A_wq, A_wo, B_x, B_w_gate, B_w_up, B_w_down):
    def _A_ref(x, k_cache, v_cache, wq, wo):
        B, Sq, D = x.shape
        Hq, Dh = 16, 256
        Hkv = k_cache.shape[1]
        rep = Hq // Hkv
        q = (lambda x, *d: x.permute(*d))((x @ wq).reshape(B, Sq, Hq, Dh), 0, 2, 1, 3)
        k = (lambda x, n, axis: torch.repeat_interleave(x, n, dim=axis))(k_cache, rep, axis=1)
        v = (lambda x, n, axis: torch.repeat_interleave(x, n, dim=axis))(v_cache, rep, axis=1)
        scores = torch.einsum("bhqd,bhkd->bhqk", q, k) * (Dh ** -0.5)
        p = _softmax(scores, axis=-1)
        o = torch.einsum("bhqk,bhkd->bhqd", p, v)
        return (lambda x, *d: x.permute(*d))(o, 0, 2, 1, 3).reshape(B, Sq, Hq * Dh) @ wo

    def _B_ref(x, w_gate, w_up, w_down):
        g = torch.einsum("bsd,df->bsf", x, w_gate)
        u = torch.einsum("bsd,df->bsf", x, w_up)
        h = g * u
        return torch.einsum("bsf,fd->bsd", h, w_down)

    x = A_x
    xn = _layernorm(x, axis=-1)
    s = _A_ref(xn, A_k_cache, A_v_cache, A_wq, A_wo)
    g = _silu(_B_ref(xn, B_w_gate, B_w_up, B_w_down))
    return x + s * g
```

```asm
; @launch grid=(256,1,1) block=(512,1,1) lds=150528
.amdgcn_target "amdgcn-amd-amdhsa--gfx950"
.text
.globl recurrent_scan__gqa_block_cached__glu_gated_bilinear__decode_kernel
.p2align 8
.type recurrent_scan__gqa_block_cached__glu_gated_bilinear__decode_kernel,@function
recurrent_scan__gqa_block_cached__glu_gated_bilinear__decode_kernel:
  s_cmp_ge_u32 s2, 256
  s_cbranch_scc1 L_exit
  s_load_dwordx16 s[16:31], s[0:1], 0
  s_load_dwordx8 s[64:71], s[0:1], 64
  v_lshrrev_b32 v2, 6, v0
  v_and_b32 v1, 63, v0
  v_mov_b32 v6, 0
  v_mov_b32 v8, 0
  v_mov_b32 v9, 0
  v_mov_b32 v10, 0
  v_mov_b32 v11, 0
  ds_write_b128 v6, v[8:11] offset:18944
  ds_write_b128 v6, v[8:11] offset:18960
  v_readfirstlane_b32 s3, v2
  s_waitcnt lgkmcnt(0)
  s_load_dword s72, s[70:71], 0
  s_mov_b32 s12, s70
  s_mov_b32 s13, s71
  s_mov_b32 s14, 3145728
  s_mov_b32 s15, 0x20000
  s_cmp_lt_u32 s3, 4
  s_cbranch_scc1 L_helper
  s_sub_u32 s32, s3, 4
  s_lshl_b32 s4, s2, 20
  s_add_u32 s8, s20, s4
  s_addc_u32 s9, s21, 0
  s_add_u32 s4, s18, s4
  s_addc_u32 s5, s19, 0
  s_mov_b32 s6, 0x100000
  s_mov_b32 s7, 0x20000
  s_mov_b32 s10, 0x100000
  s_mov_b32 s11, 0x20000
  v_and_b32 v4, 15, v1
  v_lshrrev_b32 v5, 4, v1
  v_lshlrev_b32 v2, 9, v4
  v_lshl_add_u32 v2, v5, 4, v2
  v_lshlrev_b32 v3, 11, v5
  v_lshl_add_u32 v3, v4, 4, v3
  s_lshl_b32 s34, s32, 13
  v_lshrrev_b32 v6, 2, v4
  v_lshlrev_b32 v189, 11, v6
  v_lshl_add_u32 v189, v5, 6, v189
  v_and_b32 v6, 3, v4
  v_lshl_add_u32 v189, v6, 4, v189
  s_barrier
  v_add_u32 v190, s34, v189
  s_add_u32 s34, s34, 0x8000
  buffer_load_dwordx4 v[40:43], v190, s[4:7], 0 offen offset:0 nt
  buffer_load_dwordx4 v[44:47], v190, s[4:7], 0 offen offset:256 nt
  buffer_load_dwordx4 v[48:51], v190, s[4:7], 0 offen offset:512 nt
  buffer_load_dwordx4 v[52:55], v190, s[4:7], 0 offen offset:768 nt
  buffer_load_dwordx4 v[56:59], v190, s[4:7], 0 offen offset:1024 nt
  buffer_load_dwordx4 v[60:63], v190, s[4:7], 0 offen offset:1280 nt
  buffer_load_dwordx4 v[64:67], v190, s[4:7], 0 offen offset:1536 nt
  buffer_load_dwordx4 v[68:71], v190, s[4:7], 0 offen offset:1792 nt
  v_add_u32 v190, s34, v189
  s_add_u32 s34, s34, 0x8000
  buffer_load_dwordx4 v[72:75], v190, s[4:7], 0 offen offset:0 nt
  buffer_load_dwordx4 v[76:79], v190, s[4:7], 0 offen offset:256 nt
  buffer_load_dwordx4 v[80:83], v190, s[4:7], 0 offen offset:512 nt
  buffer_load_dwordx4 v[84:87], v190, s[4:7], 0 offen offset:768 nt
  buffer_load_dwordx4 v[88:91], v190, s[4:7], 0 offen offset:1024 nt
  buffer_load_dwordx4 v[92:95], v190, s[4:7], 0 offen offset:1280 nt
  buffer_load_dwordx4 v[96:99], v190, s[4:7], 0 offen offset:1536 nt
  buffer_load_dwordx4 v[100:103], v190, s[4:7], 0 offen offset:1792 nt
  v_add_u32 v190, s34, v189
  s_add_u32 s34, s34, 0x8000
  buffer_load_dwordx4 v[104:107], v190, s[4:7], 0 offen offset:0 nt
  buffer_load_dwordx4 v[108:111], v190, s[4:7], 0 offen offset:256 nt
  buffer_load_dwordx4 v[112:115], v190, s[4:7], 0 offen offset:512 nt
  buffer_load_dwordx4 v[116:119], v190, s[4:7], 0 offen offset:768 nt
  buffer_load_dwordx4 v[120:123], v190, s[4:7], 0 offen offset:1024 nt
  buffer_load_dwordx4 v[124:127], v190, s[4:7], 0 offen offset:1280 nt
  buffer_load_dwordx4 v[128:131], v190, s[4:7], 0 offen offset:1536 nt
  buffer_load_dwordx4 v[132:135], v190, s[4:7], 0 offen offset:1792 nt
  v_add_u32 v190, s34, v189
  s_add_u32 s34, s34, 0x8000
  buffer_load_dwordx4 v[136:139], v190, s[4:7], 0 offen offset:0 nt
  buffer_load_dwordx4 v[140:143], v190, s[4:7], 0 offen offset:256 nt
  buffer_load_dwordx4 v[144:147], v190, s[4:7], 0 offen offset:512 nt
  buffer_load_dwordx4 v[148:151], v190, s[4:7], 0 offen offset:768 nt
  buffer_load_dwordx4 v[152:155], v190, s[4:7], 0 offen offset:1024 nt
  buffer_load_dwordx4 v[156:159], v190, s[4:7], 0 offen offset:1280 nt
  buffer_load_dwordx4 v[160:163], v190, s[4:7], 0 offen offset:1536 nt
  buffer_load_dwordx4 v[164:167], v190, s[4:7], 0 offen offset:1792 nt
  s_lshl_b32 s38, s32, 14
  s_add_u32 s38, s38, 52224
  s_mov_b32 m0, s38
  v_lshl_add_u32 v187, v1, 4, s38
  v_add_u32 v190, s34, v189
  s_add_u32 s34, s34, 0x8000
  buffer_load_dwordx4 v190, s[4:7], 0 offen offset:0 nt lds
  s_add_u32 m0, m0, 768
  s_nop 0
  buffer_load_dwordx4 v190, s[4:7], 0 offen offset:256 nt lds
  s_add_u32 m0, m0, 768
  s_nop 0
  buffer_load_dwordx4 v190, s[4:7], 0 offen offset:512 nt lds
  s_add_u32 m0, m0, 768
  s_nop 0
  buffer_load_dwordx4 v190, s[4:7], 0 offen offset:768 nt lds
  s_add_u32 m0, m0, 768
  s_nop 0
  buffer_load_dwordx4 v190, s[4:7], 0 offen offset:1024 nt lds
  s_add_u32 m0, m0, 768
  s_nop 0
  buffer_load_dwordx4 v190, s[4:7], 0 offen offset:1280 nt lds
  s_add_u32 m0, m0, 768
  s_nop 0
  buffer_load_dwordx4 v190, s[4:7], 0 offen offset:1536 nt lds
  s_add_u32 m0, m0, 768
  s_nop 0
  buffer_load_dwordx4 v190, s[4:7], 0 offen offset:1792 nt lds
  s_add_u32 m0, m0, 2816
  s_nop 0
  v_add_u32 v190, s34, v189
  s_add_u32 s34, s34, 0x8000
  buffer_load_dwordx4 v190, s[4:7], 0 offen offset:0 nt lds
  s_add_u32 m0, m0, 768
  s_nop 0
  buffer_load_dwordx4 v190, s[4:7], 0 offen offset:256 nt lds
  s_add_u32 m0, m0, 768
  s_nop 0
  buffer_load_dwordx4 v190, s[4:7], 0 offen offset:512 nt lds
  s_add_u32 m0, m0, 768
  s_nop 0
  buffer_load_dwordx4 v190, s[4:7], 0 offen offset:768 nt lds
  s_add_u32 m0, m0, 768
  s_nop 0
  buffer_load_dwordx4 v190, s[4:7], 0 offen offset:1024 nt lds
  s_add_u32 m0, m0, 768
  s_nop 0
  buffer_load_dwordx4 v190, s[4:7], 0 offen offset:1280 nt lds
  s_add_u32 m0, m0, 768
  s_nop 0
  buffer_load_dwordx4 v190, s[4:7], 0 offen offset:1536 nt lds
  s_add_u32 m0, m0, 768
  s_nop 0
  buffer_load_dwordx4 v190, s[4:7], 0 offen offset:1792 nt lds
  s_add_u32 m0, m0, 2816
  s_nop 0
  s_mov_b32 s35, 1035512379
  s_mov_b32 s36, 0x05040100
  s_mov_b32 s37, 0x07060302
  s_mov_b32 s48, 0x50005
  s_mov_b32 s49, 0x50005
  s_mov_b32 s50, 0xa000a
  s_mov_b32 s51, 0xa000a
  s_mov_b32 s52, 0x500050
  s_mov_b32 s53, 0x500050
  s_mov_b32 s54, 0xa000a0
  s_mov_b32 s55, 0xa000a0
  s_mov_b32 s56, 0x5000500
  s_mov_b32 s57, 0x5000500
  s_mov_b32 s58, 0xa000a00
  s_mov_b32 s59, 0xa000a00
  s_mov_b32 s60, 0x50005000
  s_mov_b32 s61, 0x50005000
  s_mov_b32 s62, 0xa000a000
  s_mov_b32 s63, 0xa000a000
  v_lshrrev_b32 v7, 2, v4
  v_and_b32 v6, 3, v4
  v_lshlrev_b32 v6, 4, v6
  v_lshlrev_b32 v3, 2, v7
  s_mov_b32 s38, 0x6410
  v_lshrrev_b32 v3, v3, s38
  v_and_b32 v3, 7, v3
  v_lshlrev_b32 v3, 6, v3
  v_lshl_add_u32 v3, v5, 11, v3
  v_add_u32 v3, v3, v6
  v_lshlrev_b32 v209, 2, v5
  s_mov_b32 s38, 0x6410
  v_lshrrev_b32 v209, v209, s38
  v_and_b32 v209, 7, v209
  v_lshlrev_b32 v209, 6, v209
  v_bfe_u32 v211, v1, 1, 1
  v_lshl_add_u32 v211, v211, 9, v209
  v_lshl_add_u32 v211, v7, 4, v211
  v_lshl_add_u32 v209, v7, 11, v209
  v_add_u32 v209, v209, v6
  v_lshlrev_b32 v208, 2, v7
  s_mov_b32 s38, 0x7532
  v_lshrrev_b32 v208, v208, s38
  v_and_b32 v208, 7, v208
  v_lshlrev_b32 v208, 6, v208
  v_lshl_add_u32 v208, v5, 11, v208
  v_add_u32 v208, v208, v6
  v_lshlrev_b32 v210, 2, v5
  s_mov_b32 s38, 0x7532
  v_lshrrev_b32 v210, v210, s38
  v_and_b32 v210, 7, v210
  v_lshlrev_b32 v210, 6, v210
  v_bfe_u32 v212, v1, 1, 1
  v_lshl_add_u32 v212, v212, 9, v210
  v_lshl_add_u32 v212, v7, 4, v212
  v_lshl_add_u32 v210, v7, 11, v210
  v_add_u32 v210, v210, v6
  v_mov_b32 v6, 1
  v_mov_b32 v172, 0
  v_mov_b32 v173, 0
  v_mov_b32 v174, 0
  v_mov_b32 v175, 0
  v_mov_b32 v176, 0
  v_mov_b32 v177, 0
  v_mov_b32 v178, 0
  v_mov_b32 v179, 0
  v_mov_b32 v180, 0xff800000
  v_mov_b32 v181, 0
  v_bfe_u32 v182, v1, 1, 1
  v_lshlrev_b32 v182, 9, v182
  v_lshl_add_u32 v184, v5, 6, v182
  v_lshl_add_u32 v182, v5, 4, v182
  v_lshrrev_b32 v7, 2, v4
  v_lshl_add_u32 v184, v7, 4, v184
  s_mov_b32 s44, 0xf0f0f0f0
  s_mov_b32 s45, s44
  s_mov_b32 s46, 0xff00ff00
  s_mov_b32 s47, s46
  s_barrier
  ds_read_b128 v[216:219], v184 offset:7424
  ds_read_b128 v[224:227], v211 offset:7424
  ds_read_b128 v[220:223], v184 offset:7680
  ds_read_b128 v[228:231], v212 offset:7424
  s_waitcnt lgkmcnt(0)
  s_add_u32 s33, s72, 0x9e3779b9
  s_lshl_b32 s38, s32, 11
  v_and_b32 v188, 2, v1
  v_lshl_add_u32 v188, v188, 2, s38
  v_lshl_add_u32 v188, v5, 4, v188
  s_mov_b64 exec, 1
  ds_add_u32 v4, v6 offset:18944
  s_mov_b64 exec, -1
  s_waitcnt vmcnt(40)
  v_mfma_f32_16x16x32_bf16 v[192:195], v[40:43], v[216:219], 0
  v_mfma_f32_16x16x32_bf16 v[196:199], v[48:51], v[216:219], 0
  v_mfma_f32_16x16x32_bf16 v[200:203], v[56:59], v[216:219], 0
  v_mfma_f32_16x16x32_bf16 v[204:207], v[64:67], v[216:219], 0
  v_mfma_f32_16x16x32_bf16 v[192:195], v[44:47], v[220:223], v[192:195]
  v_mfma_f32_16x16x32_bf16 v[196:199], v[52:55], v[220:223], v[196:199]
  v_mfma_f32_16x16x32_bf16 v[200:203], v[60:63], v[220:223], v[200:203]
  v_mfma_f32_16x16x32_bf16 v[204:207], v[68:71], v[220:223], v[204:207]
  v_add_u32 v191, s34, v210
  v_add_u32 v190, s34, v209
  s_add_u32 s34, s34, 0x8000
  buffer_load_dwordx4 v[40:43], v190, s[4:7], 0 offen offset:0 nt
  buffer_load_dwordx4 v[44:47], v191, s[4:7], 0 offen offset:0 nt
  buffer_load_dwordx4 v[48:51], v190, s[4:7], 0 offen offset:512 nt
  buffer_load_dwordx4 v[52:55], v191, s[4:7], 0 offen offset:512 nt
  buffer_load_dwordx4 v[56:59], v190, s[4:7], 0 offen offset:1024 nt
  buffer_load_dwordx4 v[60:63], v191, s[4:7], 0 offen offset:1024 nt
  buffer_load_dwordx4 v[64:67], v190, s[4:7], 0 offen offset:1536 nt
  buffer_load_dwordx4 v[68:71], v191, s[4:7], 0 offen offset:1536 nt
  v_cndmask_b32 v192, v192, v193, s[44:45]
  v_cndmask_b32 v194, v194, v195, s[44:45]
  v_cndmask_b32 v196, v196, v197, s[44:45]
  v_cndmask_b32 v198, v198, v199, s[44:45]
  v_cndmask_b32 v200, v200, v201, s[44:45]
  v_cndmask_b32 v202, v202, v203, s[44:45]
  v_cndmask_b32 v204, v204, v205, s[44:45]
  v_cndmask_b32 v206, v206, v207, s[44:45]
  v_cndmask_b32 v168, v192, v194, s[46:47]
  v_cndmask_b32 v169, v196, v198, s[46:47]
  v_cndmask_b32 v170, v200, v202, s[46:47]
  v_cndmask_b32 v171, v204, v206, s[46:47]
  v_add_f32_dpp v168, v168, v168 row_ror:4 row_mask:0xf bank_mask:0xf
  v_add_f32_dpp v169, v169, v169 row_ror:4 row_mask:0xf bank_mask:0xf
  v_add_f32_dpp v170, v170, v170 row_ror:4 row_mask:0xf bank_mask:0xf
  v_add_f32_dpp v171, v171, v171 row_ror:4 row_mask:0xf bank_mask:0xf
  v_add_f32_dpp v168, v168, v168 row_ror:8 row_mask:0xf bank_mask:0xf
  v_add_f32_dpp v169, v169, v169 row_ror:8 row_mask:0xf bank_mask:0xf
  v_add_f32_dpp v170, v170, v170 row_ror:8 row_mask:0xf bank_mask:0xf
  v_add_f32_dpp v171, v171, v171 row_ror:8 row_mask:0xf bank_mask:0xf
  v_cvt_pk_bf16_f32 v182, v168, v169
  v_cvt_pk_bf16_f32 v183, v170, v171
  ds_write_b64 v188, v[182:183] offset:8448
  v_lshlrev_b32 v168, 16, v182
  v_and_b32 v169, 0xffff0000, v182
  v_lshlrev_b32 v170, 16, v183
  v_and_b32 v171, 0xffff0000, v183
  v_add_u32 v188, 64, v188
  v_max3_f32 v180, v168, v169, v180
  v_max3_f32 v180, v170, v171, v180
  s_mov_b64 exec, 1
  ds_add_u32 v4, v6 offset:18944
  s_mov_b64 exec, -1
  s_waitcnt vmcnt(40)
  v_mfma_f32_16x16x32_bf16 v[192:195], v[72:75], v[216:219], 0
  v_mfma_f32_16x16x32_bf16 v[196:199], v[80:83], v[216:219], 0
  v_mfma_f32_16x16x32_bf16 v[200:203], v[88:91], v[216:219], 0
  v_mfma_f32_16x16x32_bf16 v[204:207], v[96:99], v[216:219], 0
  v_mfma_f32_16x16x32_bf16 v[192:195], v[76:79], v[220:223], v[192:195]
  v_mfma_f32_16x16x32_bf16 v[196:199], v[84:87], v[220:223], v[196:199]
  v_mfma_f32_16x16x32_bf16 v[200:203], v[92:95], v[220:223], v[200:203]
  v_mfma_f32_16x16x32_bf16 v[204:207], v[100:103], v[220:223], v[204:207]
  v_add_u32 v191, s34, v210
  v_add_u32 v190, s34, v209
  s_add_u32 s34, s34, 0x8000
  buffer_load_dwordx4 v[72:75], v190, s[4:7], 0 offen offset:0 nt
  buffer_load_dwordx4 v[76:79], v191, s[4:7], 0 offen offset:0 nt
  buffer_load_dwordx4 v[80:83], v190, s[4:7], 0 offen offset:512 nt
  buffer_load_dwordx4 v[84:87], v191, s[4:7], 0 offen offset:512 nt
  buffer_load_dwordx4 v[88:91], v190, s[4:7], 0 offen offset:1024 nt
  buffer_load_dwordx4 v[92:95], v191, s[4:7], 0 offen offset:1024 nt
  buffer_load_dwordx4 v[96:99], v190, s[4:7], 0 offen offset:1536 nt
  buffer_load_dwordx4 v[100:103], v191, s[4:7], 0 offen offset:1536 nt
  v_cndmask_b32 v192, v192, v193, s[44:45]
  v_cndmask_b32 v194, v194, v195, s[44:45]
  v_cndmask_b32 v196, v196, v197, s[44:45]
  v_cndmask_b32 v198, v198, v199, s[44:45]
  v_cndmask_b32 v200, v200, v201, s[44:45]
  v_cndmask_b32 v202, v202, v203, s[44:45]
  v_cndmask_b32 v204, v204, v205, s[44:45]
  v_cndmask_b32 v206, v206, v207, s[44:45]
  v_cndmask_b32 v168, v192, v194, s[46:47]
  v_cndmask_b32 v169, v196, v198, s[46:47]
  v_cndmask_b32 v170, v200, v202, s[46:47]
  v_cndmask_b32 v171, v204, v206, s[46:47]
  v_add_f32_dpp v168, v168, v168 row_ror:4 row_mask:0xf bank_mask:0xf
  v_add_f32_dpp v169, v169, v169 row_ror:4 row_mask:0xf bank_mask:0xf
  v_add_f32_dpp v170, v170, v170 row_ror:4 row_mask:0xf bank_mask:0xf
  v_add_f32_dpp v171, v171, v171 row_ror:4 row_mask:0xf bank_mask:0xf
  v_add_f32_dpp v168, v168, v168 row_ror:8 row_mask:0xf bank_mask:0xf
  v_add_f32_dpp v169, v169, v169 row_ror:8 row_mask:0xf bank_mask:0xf
  v_add_f32_dpp v170, v170, v170 row_ror:8 row_mask:0xf bank_mask:0xf
  v_add_f32_dpp v171, v171, v171 row_ror:8 row_mask:0xf bank_mask:0xf
  v_cvt_pk_bf16_f32 v182, v168, v169
  v_cvt_pk_bf16_f32 v183, v170, v171
  ds_write_b64 v188, v[182:183] offset:8448
  v_lshlrev_b32 v168, 16, v182
  v_and_b32 v169, 0xffff0000, v182
  v_lshlrev_b32 v170, 16, v183
  v_and_b32 v171, 0xffff0000, v183
  v_add_u32 v188, 64, v188
  v_max3_f32 v180, v168, v169, v180
  v_max3_f32 v180, v170, v171, v180
  s_mov_b64 exec, 1
  ds_add_u32 v4, v6 offset:18944
  s_mov_b64 exec, -1
  s_waitcnt vmcnt(40)
  v_mfma_f32_16x16x32_bf16 v[192:195], v[104:107], v[216:219], 0
  v_mfma_f32_16x16x32_bf16 v[196:199], v[112:115], v[216:219], 0
  v_mfma_f32_16x16x32_bf16 v[200:203], v[120:123], v[216:219], 0
  v_mfma_f32_16x16x32_bf16 v[204:207], v[128:131], v[216:219], 0
  v_mfma_f32_16x16x32_bf16 v[192:195], v[108:111], v[220:223], v[192:195]
  v_mfma_f32_16x16x32_bf16 v[196:199], v[116:119], v[220:223], v[196:199]
  v_mfma_f32_16x16x32_bf16 v[200:203], v[124:127], v[220:223], v[200:203]
  v_mfma_f32_16x16x32_bf16 v[204:207], v[132:135], v[220:223], v[204:207]
  s_nop 7
  v_cndmask_b32 v192, v192, v193, s[44:45]
  v_cndmask_b32 v194, v194, v195, s[44:45]
  v_cndmask_b32 v196, v196, v197, s[44:45]
  v_cndmask_b32 v198, v198, v199, s[44:45]
  v_cndmask_b32 v200, v200, v201, s[44:45]
  v_cndmask_b32 v202, v202, v203, s[44:45]
  v_cndmask_b32 v204, v204, v205, s[44:45]
  v_cndmask_b32 v206, v206, v207, s[44:45]
  v_cndmask_b32 v168, v192, v194, s[46:47]
  v_cndmask_b32 v169, v196, v198, s[46:47]
  v_cndmask_b32 v170, v200, v202, s[46:47]
  v_cndmask_b32 v171, v204, v206, s[46:47]
  v_add_f32_dpp v168, v168, v168 row_ror:4 row_mask:0xf bank_mask:0xf
  v_add_f32_dpp v169, v169, v169 row_ror:4 row_mask:0xf bank_mask:0xf
  v_add_f32_dpp v170, v170, v170 row_ror:4 row_mask:0xf bank_mask:0xf
  v_add_f32_dpp v171, v171, v171 row_ror:4 row_mask:0xf bank_mask:0xf
  v_add_f32_dpp v168, v168, v168 row_ror:8 row_mask:0xf bank_mask:0xf
  v_add_f32_dpp v169, v169, v169 row_ror:8 row_mask:0xf bank_mask:0xf
  v_add_f32_dpp v170, v170, v170 row_ror:8 row_mask:0xf bank_mask:0xf
  v_add_f32_dpp v171, v171, v171 row_ror:8 row_mask:0xf bank_mask:0xf
  v_cvt_pk_bf16_f32 v182, v168, v169
  v_cvt_pk_bf16_f32 v183, v170, v171
  ds_write_b64 v188, v[182:183] offset:8448
  v_lshlrev_b32 v168, 16, v182
  v_and_b32 v169, 0xffff0000, v182
  v_lshlrev_b32 v170, 16, v183
  v_and_b32 v171, 0xffff0000, v183
  v_add_u32 v188, 64, v188
  v_max3_f32 v180, v168, v169, v180
  v_max3_f32 v180, v170, v171, v180
  s_mov_b64 exec, 1
  ds_add_u32 v4, v6 offset:18944
  s_mov_b64 exec, -1
  s_waitcnt vmcnt(32)
  v_mfma_f32_16x16x32_bf16 v[192:195], v[136:139], v[216:219], 0
  v_mfma_f32_16x16x32_bf16 v[196:199], v[144:147], v[216:219], 0
  v_mfma_f32_16x16x32_bf16 v[200:203], v[152:155], v[216:219], 0
  v_mfma_f32_16x16x32_bf16 v[204:207], v[160:163], v[216:219], 0
  v_mfma_f32_16x16x32_bf16 v[192:195], v[140:143], v[220:223], v[192:195]
  v_mfma_f32_16x16x32_bf16 v[196:199], v[148:151], v[220:223], v[196:199]
  v_mfma_f32_16x16x32_bf16 v[200:203], v[156:159], v[220:223], v[200:203]
  v_mfma_f32_16x16x32_bf16 v[204:207], v[164:167], v[220:223], v[204:207]
  s_nop 7
  v_cndmask_b32 v192, v192, v193, s[44:45]
  v_cndmask_b32 v194, v194, v195, s[44:45]
  v_cndmask_b32 v196, v196, v197, s[44:45]
  v_cndmask_b32 v198, v198, v199, s[44:45]
  v_cndmask_b32 v200, v200, v201, s[44:45]
  v_cndmask_b32 v202, v202, v203, s[44:45]
  v_cndmask_b32 v204, v204, v205, s[44:45]
  v_cndmask_b32 v206, v206, v207, s[44:45]
  v_cndmask_b32 v168, v192, v194, s[46:47]
  v_cndmask_b32 v169, v196, v198, s[46:47]
  v_cndmask_b32 v170, v200, v202, s[46:47]
  v_cndmask_b32 v171, v204, v206, s[46:47]
  v_add_f32_dpp v168, v168, v168 row_ror:4 row_mask:0xf bank_mask:0xf
  v_add_f32_dpp v169, v169, v169 row_ror:4 row_mask:0xf bank_mask:0xf
  v_add_f32_dpp v170, v170, v170 row_ror:4 row_mask:0xf bank_mask:0xf
  v_add_f32_dpp v171, v171, v171 row_ror:4 row_mask:0xf bank_mask:0xf
  v_add_f32_dpp v168, v168, v168 row_ror:8 row_mask:0xf bank_mask:0xf
  v_add_f32_dpp v169, v169, v169 row_ror:8 row_mask:0xf bank_mask:0xf
  v_add_f32_dpp v170, v170, v170 row_ror:8 row_mask:0xf bank_mask:0xf
  v_add_f32_dpp v171, v171, v171 row_ror:8 row_mask:0xf bank_mask:0xf
  v_cvt_pk_bf16_f32 v182, v168, v169
  v_cvt_pk_bf16_f32 v183, v170, v171
  ds_write_b64 v188, v[182:183] offset:8448
  v_lshlrev_b32 v168, 16, v182
  v_and_b32 v169, 0xffff0000, v182
  v_lshlrev_b32 v170, 16, v183
  v_and_b32 v171, 0xffff0000, v183
  v_add_u32 v188, 64, v188
  v_max3_f32 v180, v168, v169, v180
  v_max3_f32 v180, v170, v171, v180
  s_waitcnt vmcnt(16)
  ds_read_b128 v[104:107], v187 offset:0
  ds_read_b128 v[108:111], v187 offset:1024
  ds_read_b128 v[112:115], v187 offset:2048
  ds_read_b128 v[116:119], v187 offset:3072
  ds_read_b128 v[120:123], v187 offset:4096
  ds_read_b128 v[124:127], v187 offset:5120
  ds_read_b128 v[128:131], v187 offset:6144
  ds_read_b128 v[132:135], v187 offset:7168
  ds_read_b128 v[136:139], v187 offset:8192
  ds_read_b128 v[140:143], v187 offset:9216
  ds_read_b128 v[144:147], v187 offset:10240
  ds_read_b128 v[148:151], v187 offset:11264
  ds_read_b128 v[152:155], v187 offset:12288
  ds_read_b128 v[156:159], v187 offset:13312
  ds_read_b128 v[160:163], v187 offset:14336
  ds_read_b128 v[164:167], v187 offset:15360
  s_waitcnt lgkmcnt(0)
  s_mov_b64 exec, 1
  ds_add_u32 v4, v6 offset:18944
  s_mov_b64 exec, -1
  s_waitcnt vmcnt(16)
  v_mfma_f32_16x16x32_bf16 v[192:195], v[104:107], v[216:219], 0
  v_mfma_f32_16x16x32_bf16 v[196:199], v[112:115], v[216:219], 0
  v_mfma_f32_16x16x32_bf16 v[200:203], v[120:123], v[216:219], 0
  v_mfma_f32_16x16x32_bf16 v[204:207], v[128:131], v[216:219], 0
  v_mfma_f32_16x16x32_bf16 v[192:195], v[108:111], v[220:223], v[192:195]
  v_mfma_f32_16x16x32_bf16 v[196:199], v[116:119], v[220:223], v[196:199]
  v_mfma_f32_16x16x32_bf16 v[200:203], v[124:127], v[220:223], v[200:203]
  v_mfma_f32_16x16x32_bf16 v[204:207], v[132:135], v[220:223], v[204:207]
  s_nop 7
  v_cndmask_b32 v192, v192, v193, s[44:45]
  v_cndmask_b32 v194, v194, v195, s[44:45]
  v_cndmask_b32 v196, v196, v197, s[44:45]
  v_cndmask_b32 v198, v198, v199, s[44:45]
  v_cndmask_b32 v200, v200, v201, s[44:45]
  v_cndmask_b32 v202, v202, v203, s[44:45]
  v_cndmask_b32 v204, v204, v205, s[44:45]
  v_cndmask_b32 v206, v206, v207, s[44:45]
  v_cndmask_b32 v168, v192, v194, s[46:47]
  v_cndmask_b32 v169, v196, v198, s[46:47]
  v_cndmask_b32 v170, v200, v202, s[46:47]
  v_cndmask_b32 v171, v204, v206, s[46:47]
  v_add_f32_dpp v168, v168, v168 row_ror:4 row_mask:0xf bank_mask:0xf
  v_add_f32_dpp v169, v169, v169 row_ror:4 row_mask:0xf bank_mask:0xf
  v_add_f32_dpp v170, v170, v170 row_ror:4 row_mask:0xf bank_mask:0xf
  v_add_f32_dpp v171, v171, v171 row_ror:4 row_mask:0xf bank_mask:0xf
  v_add_f32_dpp v168, v168, v168 row_ror:8 row_mask:0xf bank_mask:0xf
  v_add_f32_dpp v169, v169, v169 row_ror:8 row_mask:0xf bank_mask:0xf
  v_add_f32_dpp v170, v170, v170 row_ror:8 row_mask:0xf bank_mask:0xf
  v_add_f32_dpp v171, v171, v171 row_ror:8 row_mask:0xf bank_mask:0xf
  v_cvt_pk_bf16_f32 v182, v168, v169
  v_cvt_pk_bf16_f32 v183, v170, v171
  ds_write_b64 v188, v[182:183] offset:8448
  v_lshlrev_b32 v168, 16, v182
  v_and_b32 v169, 0xffff0000, v182
  v_lshlrev_b32 v170, 16, v183
  v_and_b32 v171, 0xffff0000, v183
  v_add_u32 v188, 64, v188
  v_max3_f32 v180, v168, v169, v180
  v_max3_f32 v180, v170, v171, v180
  s_mov_b64 exec, 1
  ds_add_u32 v4, v6 offset:18944
  s_mov_b64 exec, -1
  s_waitcnt vmcnt(16)
  v_mfma_f32_16x16x32_bf16 v[192:195], v[136:139], v[216:219], 0
  v_mfma_f32_16x16x32_bf16 v[196:199], v[144:147], v[216:219], 0
  v_mfma_f32_16x16x32_bf16 v[200:203], v[152:155], v[216:219], 0
  v_mfma_f32_16x16x32_bf16 v[204:207], v[160:163], v[216:219], 0
  v_mfma_f32_16x16x32_bf16 v[192:195], v[140:143], v[220:223], v[192:195]
  v_mfma_f32_16x16x32_bf16 v[196:199], v[148:151], v[220:223], v[196:199]
  v_mfma_f32_16x16x32_bf16 v[200:203], v[156:159], v[220:223], v[200:203]
  v_mfma_f32_16x16x32_bf16 v[204:207], v[164:167], v[220:223], v[204:207]
  s_nop 7
  v_cndmask_b32 v192, v192, v193, s[44:45]
  v_cndmask_b32 v194, v194, v195, s[44:45]
  v_cndmask_b32 v196, v196, v197, s[44:45]
  v_cndmask_b32 v198, v198, v199, s[44:45]
  v_cndmask_b32 v200, v200, v201, s[44:45]
  v_cndmask_b32 v202, v202, v203, s[44:45]
  v_cndmask_b32 v204, v204, v205, s[44:45]
  v_cndmask_b32 v206, v206, v207, s[44:45]
  v_cndmask_b32 v168, v192, v194, s[46:47]
  v_cndmask_b32 v169, v196, v198, s[46:47]
  v_cndmask_b32 v170, v200, v202, s[46:47]
  v_cndmask_b32 v171, v204, v206, s[46:47]
  v_add_f32_dpp v168, v168, v168 row_ror:4 row_mask:0xf bank_mask:0xf
  v_add_f32_dpp v169, v169, v169 row_ror:4 row_mask:0xf bank_mask:0xf
  v_add_f32_dpp v170, v170, v170 row_ror:4 row_mask:0xf bank_mask:0xf
  v_add_f32_dpp v171, v171, v171 row_ror:4 row_mask:0xf bank_mask:0xf
  v_add_f32_dpp v168, v168, v168 row_ror:8 row_mask:0xf bank_mask:0xf
  v_add_f32_dpp v169, v169, v169 row_ror:8 row_mask:0xf bank_mask:0xf
  v_add_f32_dpp v170, v170, v170 row_ror:8 row_mask:0xf bank_mask:0xf
  v_add_f32_dpp v171, v171, v171 row_ror:8 row_mask:0xf bank_mask:0xf
  v_cvt_pk_bf16_f32 v182, v168, v169
  v_cvt_pk_bf16_f32 v183, v170, v171
  ds_write_b64 v188, v[182:183] offset:8448
  v_lshlrev_b32 v168, 16, v182
  v_and_b32 v169, 0xffff0000, v182
  v_lshlrev_b32 v170, 16, v183
  v_and_b32 v171, 0xffff0000, v183
  v_add_u32 v188, 64, v188
  v_max3_f32 v180, v168, v169, v180
  v_max3_f32 v180, v170, v171, v180
  s_mov_b32 s38, 12
L_run_1:
  s_mov_b64 exec, 1
  ds_add_u32 v4, v6 offset:18944
  s_mov_b64 exec, -1
  s_waitcnt vmcnt(8)
  v_mfma_f32_16x16x32_bf16 v[192:195], v[40:43], v[224:227], 0
  v_mfma_f32_16x16x32_bf16 v[196:199], v[48:51], v[224:227], 0
  v_mfma_f32_16x16x32_bf16 v[200:203], v[56:59], v[224:227], 0
  v_mfma_f32_16x16x32_bf16 v[204:207], v[64:67], v[224:227], 0
  v_mfma_f32_16x16x32_bf16 v[192:195], v[44:47], v[228:231], v[192:195]
  v_mfma_f32_16x16x32_bf16 v[196:199], v[52:55], v[228:231], v[196:199]
  v_mfma_f32_16x16x32_bf16 v[200:203], v[60:63], v[228:231], v[200:203]
  v_mfma_f32_16x16x32_bf16 v[204:207], v[68:71], v[228:231], v[204:207]
  v_add_u32 v191, s34, v210
  v_add_u32 v190, s34, v209
  s_add_u32 s34, s34, 0x8000
  buffer_load_dwordx4 v[40:43], v190, s[4:7], 0 offen offset:0 nt
  buffer_load_dwordx4 v[44:47], v191, s[4:7], 0 offen offset:0 nt
  buffer_load_dwordx4 v[48:51], v190, s[4:7], 0 offen offset:512 nt
  buffer_load_dwordx4 v[52:55], v191, s[4:7], 0 offen offset:512 nt
  buffer_load_dwordx4 v[56:59], v190, s[4:7], 0 offen offset:1024 nt
  buffer_load_dwordx4 v[60:63], v191, s[4:7], 0 offen offset:1024 nt
  buffer_load_dwordx4 v[64:67], v190, s[4:7], 0 offen offset:1536 nt
  buffer_load_dwordx4 v[68:71], v191, s[4:7], 0 offen offset:1536 nt
  v_cndmask_b32 v192, v192, v193, s[44:45]
  v_cndmask_b32 v194, v194, v195, s[44:45]
  v_cndmask_b32 v196, v196, v197, s[44:45]
  v_cndmask_b32 v198, v198, v199, s[44:45]
  v_cndmask_b32 v200, v200, v201, s[44:45]
  v_cndmask_b32 v202, v202, v203, s[44:45]
  v_cndmask_b32 v204, v204, v205, s[44:45]
  v_cndmask_b32 v206, v206, v207, s[44:45]
  v_cndmask_b32 v168, v192, v194, s[46:47]
  v_cndmask_b32 v169, v196, v198, s[46:47]
  v_cndmask_b32 v170, v200, v202, s[46:47]
  v_cndmask_b32 v171, v204, v206, s[46:47]
  v_add_f32_dpp v168, v168, v168 row_ror:4 row_mask:0xf bank_mask:0xf
  v_add_f32_dpp v169, v169, v169 row_ror:4 row_mask:0xf bank_mask:0xf
  v_add_f32_dpp v170, v170, v170 row_ror:4 row_mask:0xf bank_mask:0xf
  v_add_f32_dpp v171, v171, v171 row_ror:4 row_mask:0xf bank_mask:0xf
  v_add_f32_dpp v168, v168, v168 row_ror:8 row_mask:0xf bank_mask:0xf
  v_add_f32_dpp v169, v169, v169 row_ror:8 row_mask:0xf bank_mask:0xf
  v_add_f32_dpp v170, v170, v170 row_ror:8 row_mask:0xf bank_mask:0xf
  v_add_f32_dpp v171, v171, v171 row_ror:8 row_mask:0xf bank_mask:0xf
  v_cvt_pk_bf16_f32 v182, v168, v169
  v_cvt_pk_bf16_f32 v183, v170, v171
  ds_write_b64 v188, v[182:183] offset:8448
  v_lshlrev_b32 v168, 16, v182
  v_and_b32 v169, 0xffff0000, v182
  v_lshlrev_b32 v170, 16, v183
  v_and_b32 v171, 0xffff0000, v183
  v_add_u32 v188, 64, v188
  v_max3_f32 v180, v168, v169, v180
  v_max3_f32 v180, v170, v171, v180
  s_mov_b64 exec, 1
  ds_add_u32 v4, v6 offset:18944
  s_mov_b64 exec, -1
  s_waitcnt vmcnt(8)
  v_mfma_f32_16x16x32_bf16 v[192:195], v[72:75], v[224:227], 0
  v_mfma_f32_16x16x32_bf16 v[196:199], v[80:83], v[224:227], 0
  v_mfma_f32_16x16x32_bf16 v[200:203], v[88:91], v[224:227], 0
  v_mfma_f32_16x16x32_bf16 v[204:207], v[96:99], v[224:227], 0
  v_mfma_f32_16x16x32_bf16 v[192:195], v[76:79], v[228:231], v[192:195]
  v_mfma_f32_16x16x32_bf16 v[196:199], v[84:87], v[228:231], v[196:199]
  v_mfma_f32_16x16x32_bf16 v[200:203], v[92:95], v[228:231], v[200:203]
  v_mfma_f32_16x16x32_bf16 v[204:207], v[100:103], v[228:231], v[204:207]
  v_add_u32 v191, s34, v210
  v_add_u32 v190, s34, v209
  s_add_u32 s34, s34, 0x8000
  buffer_load_dwordx4 v[72:75], v190, s[4:7], 0 offen offset:0 nt
  buffer_load_dwordx4 v[76:79], v191, s[4:7], 0 offen offset:0 nt
  buffer_load_dwordx4 v[80:83], v190, s[4:7], 0 offen offset:512 nt
  buffer_load_dwordx4 v[84:87], v191, s[4:7], 0 offen offset:512 nt
  buffer_load_dwordx4 v[88:91], v190, s[4:7], 0 offen offset:1024 nt
  buffer_load_dwordx4 v[92:95], v191, s[4:7], 0 offen offset:1024 nt
  buffer_load_dwordx4 v[96:99], v190, s[4:7], 0 offen offset:1536 nt
  buffer_load_dwordx4 v[100:103], v191, s[4:7], 0 offen offset:1536 nt
  v_cndmask_b32 v192, v192, v193, s[44:45]
  v_cndmask_b32 v194, v194, v195, s[44:45]
  v_cndmask_b32 v196, v196, v197, s[44:45]
  v_cndmask_b32 v198, v198, v199, s[44:45]
  v_cndmask_b32 v200, v200, v201, s[44:45]
  v_cndmask_b32 v202, v202, v203, s[44:45]
  v_cndmask_b32 v204, v204, v205, s[44:45]
  v_cndmask_b32 v206, v206, v207, s[44:45]
  v_cndmask_b32 v168, v192, v194, s[46:47]
  v_cndmask_b32 v169, v196, v198, s[46:47]
  v_cndmask_b32 v170, v200, v202, s[46:47]
  v_cndmask_b32 v171, v204, v206, s[46:47]
  v_add_f32_dpp v168, v168, v168 row_ror:4 row_mask:0xf bank_mask:0xf
  v_add_f32_dpp v169, v169, v169 row_ror:4 row_mask:0xf bank_mask:0xf
  v_add_f32_dpp v170, v170, v170 row_ror:4 row_mask:0xf bank_mask:0xf
  v_add_f32_dpp v171, v171, v171 row_ror:4 row_mask:0xf bank_mask:0xf
  v_add_f32_dpp v168, v168, v168 row_ror:8 row_mask:0xf bank_mask:0xf
  v_add_f32_dpp v169, v169, v169 row_ror:8 row_mask:0xf bank_mask:0xf
  v_add_f32_dpp v170, v170, v170 row_ror:8 row_mask:0xf bank_mask:0xf
  v_add_f32_dpp v171, v171, v171 row_ror:8 row_mask:0xf bank_mask:0xf
  v_cvt_pk_bf16_f32 v182, v168, v169
  v_cvt_pk_bf16_f32 v183, v170, v171
  ds_write_b64 v188, v[182:183] offset:8448
  v_lshlrev_b32 v168, 16, v182
  v_and_b32 v169, 0xffff0000, v182
  v_lshlrev_b32 v170, 16, v183
  v_and_b32 v171, 0xffff0000, v183
  v_add_u32 v188, 64, v188
  v_max3_f32 v180, v168, v169, v180
  v_max3_f32 v180, v170, v171, v180
  s_sub_u32 s38, s38, 1
  s_cmp_lg_u32 s38, 0
  s_cbranch_scc1 L_run_1
  s_lshl_b32 s34, s32, 13
  s_mov_b64 exec, 1
  ds_add_u32 v4, v6 offset:18944
  s_mov_b64 exec, -1
  s_waitcnt vmcnt(8)
  v_mfma_f32_16x16x32_bf16 v[192:195], v[40:43], v[224:227], 0
  v_mfma_f32_16x16x32_bf16 v[196:199], v[48:51], v[224:227], 0
  v_mfma_f32_16x16x32_bf16 v[200:203], v[56:59], v[224:227], 0
  v_mfma_f32_16x16x32_bf16 v[204:207], v[64:67], v[224:227], 0
  v_mfma_f32_16x16x32_bf16 v[192:195], v[44:47], v[228:231], v[192:195]
  v_mfma_f32_16x16x32_bf16 v[196:199], v[52:55], v[228:231], v[196:199]
  v_mfma_f32_16x16x32_bf16 v[200:203], v[60:63], v[228:231], v[200:203]
  v_mfma_f32_16x16x32_bf16 v[204:207], v[68:71], v[228:231], v[204:207]
  v_add_u32 v191, s34, v208
  v_add_u32 v190, s34, v3
  s_add_u32 s34, s34, 0x8000
  buffer_load_dwordx4 v[40:43], v190, s[8:11], 0 offen offset:0 nt
  buffer_load_dwordx4 v[44:47], v191, s[8:11], 0 offen offset:0 nt
  buffer_load_dwordx4 v[48:51], v190, s[8:11], 0 offen offset:512 nt
  buffer_load_dwordx4 v[52:55], v191, s[8:11], 0 offen offset:512 nt
  buffer_load_dwordx4 v[56:59], v190, s[8:11], 0 offen offset:1024 nt
  buffer_load_dwordx4 v[60:63], v191, s[8:11], 0 offen offset:1024 nt
  buffer_load_dwordx4 v[64:67], v190, s[8:11], 0 offen offset:1536 nt
  buffer_load_dwordx4 v[68:71], v191, s[8:11], 0 offen offset:1536 nt
  v_cndmask_b32 v192, v192, v193, s[44:45]
  v_cndmask_b32 v194, v194, v195, s[44:45]
  v_cndmask_b32 v196, v196, v197, s[44:45]
  v_cndmask_b32 v198, v198, v199, s[44:45]
  v_cndmask_b32 v200, v200, v201, s[44:45]
  v_cndmask_b32 v202, v202, v203, s[44:45]
  v_cndmask_b32 v204, v204, v205, s[44:45]
  v_cndmask_b32 v206, v206, v207, s[44:45]
  v_cndmask_b32 v168, v192, v194, s[46:47]
  v_cndmask_b32 v169, v196, v198, s[46:47]
  v_cndmask_b32 v170, v200, v202, s[46:47]
  v_cndmask_b32 v171, v204, v206, s[46:47]
  v_add_f32_dpp v168, v168, v168 row_ror:4 row_mask:0xf bank_mask:0xf
  v_add_f32_dpp v169, v169, v169 row_ror:4 row_mask:0xf bank_mask:0xf
  v_add_f32_dpp v170, v170, v170 row_ror:4 row_mask:0xf bank_mask:0xf
  v_add_f32_dpp v171, v171, v171 row_ror:4 row_mask:0xf bank_mask:0xf
  v_add_f32_dpp v168, v168, v168 row_ror:8 row_mask:0xf bank_mask:0xf
  v_add_f32_dpp v169, v169, v169 row_ror:8 row_mask:0xf bank_mask:0xf
  v_add_f32_dpp v170, v170, v170 row_ror:8 row_mask:0xf bank_mask:0xf
  v_add_f32_dpp v171, v171, v171 row_ror:8 row_mask:0xf bank_mask:0xf
  v_cvt_pk_bf16_f32 v182, v168, v169
  v_cvt_pk_bf16_f32 v183, v170, v171
  ds_write_b64 v188, v[182:183] offset:8448
  v_lshlrev_b32 v168, 16, v182
  v_and_b32 v169, 0xffff0000, v182
  v_lshlrev_b32 v170, 16, v183
  v_and_b32 v171, 0xffff0000, v183
  v_add_u32 v188, 64, v188
  v_max3_f32 v180, v168, v169, v180
  v_max3_f32 v180, v170, v171, v180
  s_mov_b64 exec, 1
  ds_add_u32 v4, v6 offset:18944
  s_mov_b64 exec, -1
  s_waitcnt vmcnt(8)
  v_mfma_f32_16x16x32_bf16 v[192:195], v[72:75], v[224:227], 0
  v_mfma_f32_16x16x32_bf16 v[196:199], v[80:83], v[224:227], 0
  v_mfma_f32_16x16x32_bf16 v[200:203], v[88:91], v[224:227], 0
  v_mfma_f32_16x16x32_bf16 v[204:207], v[96:99], v[224:227], 0
  v_mfma_f32_16x16x32_bf16 v[192:195], v[76:79], v[228:231], v[192:195]
  v_mfma_f32_16x16x32_bf16 v[196:199], v[84:87], v[228:231], v[196:199]
  v_mfma_f32_16x16x32_bf16 v[200:203], v[92:95], v[228:231], v[200:203]
  v_mfma_f32_16x16x32_bf16 v[204:207], v[100:103], v[228:231], v[204:207]
  v_add_u32 v191, s34, v208
  v_add_u32 v190, s34, v3
  s_add_u32 s34, s34, 0x8000
  buffer_load_dwordx4 v[72:75], v190, s[8:11], 0 offen offset:0 nt
  buffer_load_dwordx4 v[76:79], v191, s[8:11], 0 offen offset:0 nt
  buffer_load_dwordx4 v[80:83], v190, s[8:11], 0 offen offset:512 nt
  buffer_load_dwordx4 v[84:87], v191, s[8:11], 0 offen offset:512 nt
  buffer_load_dwordx4 v[88:91], v190, s[8:11], 0 offen offset:1024 nt
  buffer_load_dwordx4 v[92:95], v191, s[8:11], 0 offen offset:1024 nt
  buffer_load_dwordx4 v[96:99], v190, s[8:11], 0 offen offset:1536 nt
  buffer_load_dwordx4 v[100:103], v191, s[8:11], 0 offen offset:1536 nt
  v_cndmask_b32 v192, v192, v193, s[44:45]
  v_cndmask_b32 v194, v194, v195, s[44:45]
  v_cndmask_b32 v196, v196, v197, s[44:45]
  v_cndmask_b32 v198, v198, v199, s[44:45]
  v_cndmask_b32 v200, v200, v201, s[44:45]
  v_cndmask_b32 v202, v202, v203, s[44:45]
  v_cndmask_b32 v204, v204, v205, s[44:45]
  v_cndmask_b32 v206, v206, v207, s[44:45]
  v_cndmask_b32 v168, v192, v194, s[46:47]
  v_cndmask_b32 v169, v196, v198, s[46:47]
  v_cndmask_b32 v170, v200, v202, s[46:47]
  v_cndmask_b32 v171, v204, v206, s[46:47]
  v_add_f32_dpp v168, v168, v168 row_ror:4 row_mask:0xf bank_mask:0xf
  v_add_f32_dpp v169, v169, v169 row_ror:4 row_mask:0xf bank_mask:0xf
  v_add_f32_dpp v170, v170, v170 row_ror:4 row_mask:0xf bank_mask:0xf
  v_add_f32_dpp v171, v171, v171 row_ror:4 row_mask:0xf bank_mask:0xf
  v_add_f32_dpp v168, v168, v168 row_ror:8 row_mask:0xf bank_mask:0xf
  v_add_f32_dpp v169, v169, v169 row_ror:8 row_mask:0xf bank_mask:0xf
  v_add_f32_dpp v170, v170, v170 row_ror:8 row_mask:0xf bank_mask:0xf
  v_add_f32_dpp v171, v171, v171 row_ror:8 row_mask:0xf bank_mask:0xf
  v_cvt_pk_bf16_f32 v182, v168, v169
  v_cvt_pk_bf16_f32 v183, v170, v171
  ds_write_b64 v188, v[182:183] offset:8448
  v_lshlrev_b32 v168, 16, v182
  v_and_b32 v169, 0xffff0000, v182
  v_lshlrev_b32 v170, 16, v183
  v_and_b32 v171, 0xffff0000, v183
  v_add_u32 v188, 64, v188
  v_max3_f32 v180, v168, v169, v180
  v_max3_f32 v180, v170, v171, v180
  v_mov_b32 v182, v180
  s_nop 1
  v_permlane32_swap_b32 v180, v182
  s_nop 0
  v_max_f32 v180, v180, v182
  v_mov_b32 v182, v180
  s_nop 1
  v_permlane16_swap_b32 v180, v182
  s_nop 0
  v_max_f32 v180, v180, v182
  v_mul_f32 v186, s35, v180
  s_lshl_b32 s38, s32, 11
  v_and_b32 v188, 2, v1
  v_lshl_add_u32 v188, v188, 2, s38
  v_lshl_add_u32 v188, v5, 4, v188
  s_mov_b32 s38, 15
L_run_2:
  s_mov_b64 exec, 1
  ds_add_u32 v4, v6 offset:18944
  s_mov_b64 exec, -1
  ds_read_b64 v[182:183], v188 offset:8448
  v_add_u32 v188, 64, v188
  s_waitcnt lgkmcnt(0)
  v_lshlrev_b32 v168, 16, v182
  v_and_b32 v169, 0xffff0000, v182
  v_lshlrev_b32 v170, 16, v183
  v_and_b32 v171, 0xffff0000, v183
  v_fma_f32 v168, v168, s35, -v186
  v_fma_f32 v169, v169, s35, -v186
  v_fma_f32 v170, v170, s35, -v186
  v_fma_f32 v171, v171, s35, -v186
  v_exp_f32 v168, v168
  v_exp_f32 v169, v169
  v_exp_f32 v170, v170
  v_exp_f32 v171, v171
  v_add_f32 v181, v181, v168
  v_cvt_pk_bf16_f32 v184, v168, v169
  v_cvt_pk_bf16_f32 v185, v170, v171
  v_add_f32 v169, v169, v170
  v_add_f32 v181, v181, v171
  v_add_f32 v181, v181, v169
  v_cndmask_b32 v192, 0, v184, s[48:49]
  v_cndmask_b32 v193, 0, v185, s[48:49]
  v_cndmask_b32 v194, 0, v184, s[50:51]
  v_cndmask_b32 v195, 0, v185, s[50:51]
  v_cndmask_b32 v196, 0, v184, s[52:53]
  v_cndmask_b32 v197, 0, v185, s[52:53]
  v_cndmask_b32 v198, 0, v184, s[54:55]
  v_cndmask_b32 v199, 0, v185, s[54:55]
  v_cndmask_b32 v200, 0, v184, s[56:57]
  v_cndmask_b32 v201, 0, v185, s[56:57]
  v_cndmask_b32 v202, 0, v184, s[58:59]
  v_cndmask_b32 v203, 0, v185, s[58:59]
  v_cndmask_b32 v204, 0, v184, s[60:61]
  v_cndmask_b32 v205, 0, v185, s[60:61]
  v_cndmask_b32 v206, 0, v184, s[62:63]
  v_cndmask_b32 v207, 0, v185, s[62:63]
  s_waitcnt vmcnt(8)
  v_perm_b32 v104, v48, v40, s36
  v_perm_b32 v105, v64, v56, s36
  v_perm_b32 v106, v48, v40, s37
  v_perm_b32 v107, v64, v56, s37
  v_perm_b32 v108, v49, v41, s36
  v_perm_b32 v109, v65, v57, s36
  v_perm_b32 v110, v49, v41, s37
  v_perm_b32 v111, v65, v57, s37
  v_perm_b32 v112, v50, v42, s36
  v_perm_b32 v113, v66, v58, s36
  v_perm_b32 v114, v50, v42, s37
  v_perm_b32 v115, v66, v58, s37
  v_perm_b32 v116, v51, v43, s36
  v_perm_b32 v117, v67, v59, s36
  v_perm_b32 v118, v51, v43, s37
  v_perm_b32 v119, v67, v59, s37
  v_perm_b32 v120, v52, v44, s36
  v_perm_b32 v121, v68, v60, s36
  v_perm_b32 v122, v52, v44, s37
  v_perm_b32 v123, v68, v60, s37
  v_perm_b32 v124, v53, v45, s36
  v_perm_b32 v125, v69, v61, s36
  v_perm_b32 v126, v53, v45, s37
  v_perm_b32 v127, v69, v61, s37
  v_perm_b32 v128, v54, v46, s36
  v_perm_b32 v129, v70, v62, s36
  v_perm_b32 v130, v54, v46, s37
  v_perm_b32 v131, v70, v62, s37
  v_perm_b32 v132, v55, v47, s36
  v_perm_b32 v133, v71, v63, s36
  v_perm_b32 v134, v55, v47, s37
  v_perm_b32 v135, v71, v63, s37
  v_add_u32 v191, s34, v208
  v_add_u32 v190, s34, v3
  s_add_u32 s34, s34, 0x8000
  buffer_load_dwordx4 v[40:43], v190, s[8:11], 0 offen offset:0 nt
  buffer_load_dwordx4 v[44:47], v191, s[8:11], 0 offen offset:0 nt
  buffer_load_dwordx4 v[48:51], v190, s[8:11], 0 offen offset:512 nt
  buffer_load_dwordx4 v[52:55], v191, s[8:11], 0 offen offset:512 nt
  buffer_load_dwordx4 v[56:59], v190, s[8:11], 0 offen offset:1024 nt
  buffer_load_dwordx4 v[60:63], v191, s[8:11], 0 offen offset:1024 nt
  buffer_load_dwordx4 v[64:67], v190, s[8:11], 0 offen offset:1536 nt
  buffer_load_dwordx4 v[68:71], v191, s[8:11], 0 offen offset:1536 nt
  v_mfma_f32_16x16x16_bf16 v[172:175], v[192:193], v[104:105], v[172:175]
  v_mfma_f32_16x16x16_bf16 v[176:179], v[192:193], v[120:121], v[176:179]
  v_mfma_f32_16x16x16_bf16 v[172:175], v[194:195], v[106:107], v[172:175]
  v_mfma_f32_16x16x16_bf16 v[176:179], v[194:195], v[122:123], v[176:179]
  v_mfma_f32_16x16x16_bf16 v[172:175], v[196:197], v[108:109], v[172:175]
  v_mfma_f32_16x16x16_bf16 v[176:179], v[196:197], v[124:125], v[176:179]
  v_mfma_f32_16x16x16_bf16 v[172:175], v[198:199], v[110:111], v[172:175]
  v_mfma_f32_16x16x16_bf16 v[176:179], v[198:199], v[126:127], v[176:179]
  v_mfma_f32_16x16x16_bf16 v[172:175], v[200:201], v[112:113], v[172:175]
  v_mfma_f32_16x16x16_bf16 v[176:179], v[200:201], v[128:129], v[176:179]
  v_mfma_f32_16x16x16_bf16 v[172:175], v[202:203], v[114:115], v[172:175]
  v_mfma_f32_16x16x16_bf16 v[176:179], v[202:203], v[130:131], v[176:179]
  v_mfma_f32_16x16x16_bf16 v[172:175], v[204:205], v[116:117], v[172:175]
  v_mfma_f32_16x16x16_bf16 v[176:179], v[204:205], v[132:133], v[176:179]
  v_mfma_f32_16x16x16_bf16 v[172:175], v[206:207], v[118:119], v[172:175]
  v_mfma_f32_16x16x16_bf16 v[176:179], v[206:207], v[134:135], v[176:179]
  s_mov_b64 exec, 1
  ds_add_u32 v4, v6 offset:18944
  s_mov_b64 exec, -1
  ds_read_b64 v[182:183], v188 offset:8448
  v_add_u32 v188, 64, v188
  s_waitcnt lgkmcnt(0)
  v_lshlrev_b32 v168, 16, v182
  v_and_b32 v169, 0xffff0000, v182
  v_lshlrev_b32 v170, 16, v183
  v_and_b32 v171, 0xffff0000, v183
  v_fma_f32 v168, v168, s35, -v186
  v_fma_f32 v169, v169, s35, -v186
  v_fma_f32 v170, v170, s35, -v186
  v_fma_f32 v171, v171, s35, -v186
  v_exp_f32 v168, v168
  v_exp_f32 v169, v169
  v_exp_f32 v170, v170
  v_exp_f32 v171, v171
  v_add_f32 v181, v181, v168
  v_cvt_pk_bf16_f32 v184, v168, v169
  v_cvt_pk_bf16_f32 v185, v170, v171
  v_add_f32 v169, v169, v170
  v_add_f32 v181, v181, v171
  v_add_f32 v181, v181, v169
  v_cndmask_b32 v192, 0, v184, s[48:49]
  v_cndmask_b32 v193, 0, v185, s[48:49]
  v_cndmask_b32 v194, 0, v184, s[50:51]
  v_cndmask_b32 v195, 0, v185, s[50:51]
  v_cndmask_b32 v196, 0, v184, s[52:53]
  v_cndmask_b32 v197, 0, v185, s[52:53]
  v_cndmask_b32 v198, 0, v184, s[54:55]
  v_cndmask_b32 v199, 0, v185, s[54:55]
  v_cndmask_b32 v200, 0, v184, s[56:57]
  v_cndmask_b32 v201, 0, v185, s[56:57]
  v_cndmask_b32 v202, 0, v184, s[58:59]
  v_cndmask_b32 v203, 0, v185, s[58:59]
  v_cndmask_b32 v204, 0, v184, s[60:61]
  v_cndmask_b32 v205, 0, v185, s[60:61]
  v_cndmask_b32 v206, 0, v184, s[62:63]
  v_cndmask_b32 v207, 0, v185, s[62:63]
  s_waitcnt vmcnt(8)
  v_perm_b32 v104, v80, v72, s36
  v_perm_b32 v105, v96, v88, s36
  v_perm_b32 v106, v80, v72, s37
  v_perm_b32 v107, v96, v88, s37
  v_perm_b32 v108, v81, v73, s36
  v_perm_b32 v109, v97, v89, s36
  v_perm_b32 v110, v81, v73, s37
  v_perm_b32 v111, v97, v89, s37
  v_perm_b32 v112, v82, v74, s36
  v_perm_b32 v113, v98, v90, s36
  v_perm_b32 v114, v82, v74, s37
  v_perm_b32 v115, v98, v90, s37
  v_perm_b32 v116, v83, v75, s36
  v_perm_b32 v117, v99, v91, s36
  v_perm_b32 v118, v83, v75, s37
  v_perm_b32 v119, v99, v91, s37
  v_perm_b32 v120, v84, v76, s36
  v_perm_b32 v121, v100, v92, s36
  v_perm_b32 v122, v84, v76, s37
  v_perm_b32 v123, v100, v92, s37
  v_perm_b32 v124, v85, v77, s36
  v_perm_b32 v125, v101, v93, s36
  v_perm_b32 v126, v85, v77, s37
  v_perm_b32 v127, v101, v93, s37
  v_perm_b32 v128, v86, v78, s36
  v_perm_b32 v129, v102, v94, s36
  v_perm_b32 v130, v86, v78, s37
  v_perm_b32 v131, v102, v94, s37
  v_perm_b32 v132, v87, v79, s36
  v_perm_b32 v133, v103, v95, s36
  v_perm_b32 v134, v87, v79, s37
  v_perm_b32 v135, v103, v95, s37
  v_add_u32 v191, s34, v208
  v_add_u32 v190, s34, v3
  s_add_u32 s34, s34, 0x8000
  buffer_load_dwordx4 v[72:75], v190, s[8:11], 0 offen offset:0 nt
  buffer_load_dwordx4 v[76:79], v191, s[8:11], 0 offen offset:0 nt
  buffer_load_dwordx4 v[80:83], v190, s[8:11], 0 offen offset:512 nt
  buffer_load_dwordx4 v[84:87], v191, s[8:11], 0 offen offset:512 nt
  buffer_load_dwordx4 v[88:91], v190, s[8:11], 0 offen offset:1024 nt
  buffer_load_dwordx4 v[92:95], v191, s[8:11], 0 offen offset:1024 nt
  buffer_load_dwordx4 v[96:99], v190, s[8:11], 0 offen offset:1536 nt
  buffer_load_dwordx4 v[100:103], v191, s[8:11], 0 offen offset:1536 nt
  v_mfma_f32_16x16x16_bf16 v[172:175], v[192:193], v[104:105], v[172:175]
  v_mfma_f32_16x16x16_bf16 v[176:179], v[192:193], v[120:121], v[176:179]
  v_mfma_f32_16x16x16_bf16 v[172:175], v[194:195], v[106:107], v[172:175]
  v_mfma_f32_16x16x16_bf16 v[176:179], v[194:195], v[122:123], v[176:179]
  v_mfma_f32_16x16x16_bf16 v[172:175], v[196:197], v[108:109], v[172:175]
  v_mfma_f32_16x16x16_bf16 v[176:179], v[196:197], v[124:125], v[176:179]
  v_mfma_f32_16x16x16_bf16 v[172:175], v[198:199], v[110:111], v[172:175]
  v_mfma_f32_16x16x16_bf16 v[176:179], v[198:199], v[126:127], v[176:179]
  v_mfma_f32_16x16x16_bf16 v[172:175], v[200:201], v[112:113], v[172:175]
  v_mfma_f32_16x16x16_bf16 v[176:179], v[200:201], v[128:129], v[176:179]
  v_mfma_f32_16x16x16_bf16 v[172:175], v[202:203], v[114:115], v[172:175]
  v_mfma_f32_16x16x16_bf16 v[176:179], v[202:203], v[130:131], v[176:179]
  v_mfma_f32_16x16x16_bf16 v[172:175], v[204:205], v[116:117], v[172:175]
  v_mfma_f32_16x16x16_bf16 v[176:179], v[204:205], v[132:133], v[176:179]
  v_mfma_f32_16x16x16_bf16 v[172:175], v[206:207], v[118:119], v[172:175]
  v_mfma_f32_16x16x16_bf16 v[176:179], v[206:207], v[134:135], v[176:179]
  s_sub_u32 s38, s38, 1
  s_cmp_lg_u32 s38, 0
  s_cbranch_scc1 L_run_2
  s_mov_b64 exec, 1
  ds_add_u32 v4, v6 offset:18944
  s_mov_b64 exec, -1
  ds_read_b64 v[182:183], v188 offset:8448
  v_add_u32 v188, 64, v188
  s_waitcnt lgkmcnt(0)
  v_lshlrev_b32 v168, 16, v182
  v_and_b32 v169, 0xffff0000, v182
  v_lshlrev_b32 v170, 16, v183
  v_and_b32 v171, 0xffff0000, v183
  v_fma_f32 v168, v168, s35, -v186
  v_fma_f32 v169, v169, s35, -v186
  v_fma_f32 v170, v170, s35, -v186
  v_fma_f32 v171, v171, s35, -v186
  v_exp_f32 v168, v168
  v_exp_f32 v169, v169
  v_exp_f32 v170, v170
  v_exp_f32 v171, v171
  v_add_f32 v181, v181, v168
  v_cvt_pk_bf16_f32 v184, v168, v169
  v_cvt_pk_bf16_f32 v185, v170, v171
  v_add_f32 v169, v169, v170
  v_add_f32 v181, v181, v171
  v_add_f32 v181, v181, v169
  v_cndmask_b32 v192, 0, v184, s[48:49]
  v_cndmask_b32 v193, 0, v185, s[48:49]
  v_cndmask_b32 v194, 0, v184, s[50:51]
  v_cndmask_b32 v195, 0, v185, s[50:51]
  v_cndmask_b32 v196, 0, v184, s[52:53]
  v_cndmask_b32 v197, 0, v185, s[52:53]
  v_cndmask_b32 v198, 0, v184, s[54:55]
  v_cndmask_b32 v199, 0, v185, s[54:55]
  v_cndmask_b32 v200, 0, v184, s[56:57]
  v_cndmask_b32 v201, 0, v185, s[56:57]
  v_cndmask_b32 v202, 0, v184, s[58:59]
  v_cndmask_b32 v203, 0, v185, s[58:59]
  v_cndmask_b32 v204, 0, v184, s[60:61]
  v_cndmask_b32 v205, 0, v185, s[60:61]
  v_cndmask_b32 v206, 0, v184, s[62:63]
  v_cndmask_b32 v207, 0, v185, s[62:63]
  s_waitcnt vmcnt(8)
  v_perm_b32 v104, v48, v40, s36
  v_perm_b32 v105, v64, v56, s36
  v_perm_b32 v106, v48, v40, s37
  v_perm_b32 v107, v64, v56, s37
  v_perm_b32 v108, v49, v41, s36
  v_perm_b32 v109, v65, v57, s36
  v_perm_b32 v110, v49, v41, s37
  v_perm_b32 v111, v65, v57, s37
  v_perm_b32 v112, v50, v42, s36
  v_perm_b32 v113, v66, v58, s36
  v_perm_b32 v114, v50, v42, s37
  v_perm_b32 v115, v66, v58, s37
  v_perm_b32 v116, v51, v43, s36
  v_perm_b32 v117, v67, v59, s36
  v_perm_b32 v118, v51, v43, s37
  v_perm_b32 v119, v67, v59, s37
  v_perm_b32 v120, v52, v44, s36
  v_perm_b32 v121, v68, v60, s36
  v_perm_b32 v122, v52, v44, s37
  v_perm_b32 v123, v68, v60, s37
  v_perm_b32 v124, v53, v45, s36
  v_perm_b32 v125, v69, v61, s36
  v_perm_b32 v126, v53, v45, s37
  v_perm_b32 v127, v69, v61, s37
  v_perm_b32 v128, v54, v46, s36
  v_perm_b32 v129, v70, v62, s36
  v_perm_b32 v130, v54, v46, s37
  v_perm_b32 v131, v70, v62, s37
  v_perm_b32 v132, v55, v47, s36
  v_perm_b32 v133, v71, v63, s36
  v_perm_b32 v134, v55, v47, s37
  v_perm_b32 v135, v71, v63, s37
  v_mfma_f32_16x16x16_bf16 v[172:175], v[192:193], v[104:105], v[172:175]
  v_mfma_f32_16x16x16_bf16 v[176:179], v[192:193], v[120:121], v[176:179]
  v_mfma_f32_16x16x16_bf16 v[172:175], v[194:195], v[106:107], v[172:175]
  v_mfma_f32_16x16x16_bf16 v[176:179], v[194:195], v[122:123], v[176:179]
  v_mfma_f32_16x16x16_bf16 v[172:175], v[196:197], v[108:109], v[172:175]
  v_mfma_f32_16x16x16_bf16 v[176:179], v[196:197], v[124:125], v[176:179]
  v_mfma_f32_16x16x16_bf16 v[172:175], v[198:199], v[110:111], v[172:175]
  v_mfma_f32_16x16x16_bf16 v[176:179], v[198:199], v[126:127], v[176:179]
  v_mfma_f32_16x16x16_bf16 v[172:175], v[200:201], v[112:113], v[172:175]
  v_mfma_f32_16x16x16_bf16 v[176:179], v[200:201], v[128:129], v[176:179]
  v_mfma_f32_16x16x16_bf16 v[172:175], v[202:203], v[114:115], v[172:175]
  v_mfma_f32_16x16x16_bf16 v[176:179], v[202:203], v[130:131], v[176:179]
  v_mfma_f32_16x16x16_bf16 v[172:175], v[204:205], v[116:117], v[172:175]
  v_mfma_f32_16x16x16_bf16 v[176:179], v[204:205], v[132:133], v[176:179]
  v_mfma_f32_16x16x16_bf16 v[172:175], v[206:207], v[118:119], v[172:175]
  v_mfma_f32_16x16x16_bf16 v[176:179], v[206:207], v[134:135], v[176:179]
  s_mov_b64 exec, 1
  ds_add_u32 v4, v6 offset:18944
  s_mov_b64 exec, -1
  ds_read_b64 v[182:183], v188 offset:8448
  v_add_u32 v188, 64, v188
  s_waitcnt lgkmcnt(0)
  v_lshlrev_b32 v168, 16, v182
  v_and_b32 v169, 0xffff0000, v182
  v_lshlrev_b32 v170, 16, v183
  v_and_b32 v171, 0xffff0000, v183
  v_fma_f32 v168, v168, s35, -v186
  v_fma_f32 v169, v169, s35, -v186
  v_fma_f32 v170, v170, s35, -v186
  v_fma_f32 v171, v171, s35, -v186
  v_exp_f32 v168, v168
  v_exp_f32 v169, v169
  v_exp_f32 v170, v170
  v_exp_f32 v171, v171
  v_add_f32 v181, v181, v168
  v_cvt_pk_bf16_f32 v184, v168, v169
  v_cvt_pk_bf16_f32 v185, v170, v171
  v_add_f32 v169, v169, v170
  v_add_f32 v181, v181, v171
  v_add_f32 v181, v181, v169
  v_cndmask_b32 v192, 0, v184, s[48:49]
  v_cndmask_b32 v193, 0, v185, s[48:49]
  v_cndmask_b32 v194, 0, v184, s[50:51]
  v_cndmask_b32 v195, 0, v185, s[50:51]
  v_cndmask_b32 v196, 0, v184, s[52:53]
  v_cndmask_b32 v197, 0, v185, s[52:53]
  v_cndmask_b32 v198, 0, v184, s[54:55]
  v_cndmask_b32 v199, 0, v185, s[54:55]
  v_cndmask_b32 v200, 0, v184, s[56:57]
  v_cndmask_b32 v201, 0, v185, s[56:57]
  v_cndmask_b32 v202, 0, v184, s[58:59]
  v_cndmask_b32 v203, 0, v185, s[58:59]
  v_cndmask_b32 v204, 0, v184, s[60:61]
  v_cndmask_b32 v205, 0, v185, s[60:61]
  v_cndmask_b32 v206, 0, v184, s[62:63]
  v_cndmask_b32 v207, 0, v185, s[62:63]
  s_waitcnt vmcnt(0)
  v_perm_b32 v104, v80, v72, s36
  v_perm_b32 v105, v96, v88, s36
  v_perm_b32 v106, v80, v72, s37
  v_perm_b32 v107, v96, v88, s37
  v_perm_b32 v108, v81, v73, s36
  v_perm_b32 v109, v97, v89, s36
  v_perm_b32 v110, v81, v73, s37
  v_perm_b32 v111, v97, v89, s37
  v_perm_b32 v112, v82, v74, s36
  v_perm_b32 v113, v98, v90, s36
  v_perm_b32 v114, v82, v74, s37
  v_perm_b32 v115, v98, v90, s37
  v_perm_b32 v116, v83, v75, s36
  v_perm_b32 v117, v99, v91, s36
  v_perm_b32 v118, v83, v75, s37
  v_perm_b32 v119, v99, v91, s37
  v_perm_b32 v120, v84, v76, s36
  v_perm_b32 v121, v100, v92, s36
  v_perm_b32 v122, v84, v76, s37
  v_perm_b32 v123, v100, v92, s37
  v_perm_b32 v124, v85, v77, s36
  v_perm_b32 v125, v101, v93, s36
  v_perm_b32 v126, v85, v77, s37
  v_perm_b32 v127, v101, v93, s37
  v_perm_b32 v128, v86, v78, s36
  v_perm_b32 v129, v102, v94, s36
  v_perm_b32 v130, v86, v78, s37
  v_perm_b32 v131, v102, v94, s37
  v_perm_b32 v132, v87, v79, s36
  v_perm_b32 v133, v103, v95, s36
  v_perm_b32 v134, v87, v79, s37
  v_perm_b32 v135, v103, v95, s37
  v_mfma_f32_16x16x16_bf16 v[172:175], v[192:193], v[104:105], v[172:175]
  v_mfma_f32_16x16x16_bf16 v[176:179], v[192:193], v[120:121], v[176:179]
  v_mfma_f32_16x16x16_bf16 v[172:175], v[194:195], v[106:107], v[172:175]
  v_mfma_f32_16x16x16_bf16 v[176:179], v[194:195], v[122:123], v[176:179]
  v_mfma_f32_16x16x16_bf16 v[172:175], v[196:197], v[108:109], v[172:175]
  v_mfma_f32_16x16x16_bf16 v[176:179], v[196:197], v[124:125], v[176:179]
  v_mfma_f32_16x16x16_bf16 v[172:175], v[198:199], v[110:111], v[172:175]
  v_mfma_f32_16x16x16_bf16 v[176:179], v[198:199], v[126:127], v[176:179]
  v_mfma_f32_16x16x16_bf16 v[172:175], v[200:201], v[112:113], v[172:175]
  v_mfma_f32_16x16x16_bf16 v[176:179], v[200:201], v[128:129], v[176:179]
  v_mfma_f32_16x16x16_bf16 v[172:175], v[202:203], v[114:115], v[172:175]
  v_mfma_f32_16x16x16_bf16 v[176:179], v[202:203], v[130:131], v[176:179]
  v_mfma_f32_16x16x16_bf16 v[172:175], v[204:205], v[116:117], v[172:175]
  v_mfma_f32_16x16x16_bf16 v[176:179], v[204:205], v[132:133], v[176:179]
  v_mfma_f32_16x16x16_bf16 v[172:175], v[206:207], v[118:119], v[172:175]
  v_mfma_f32_16x16x16_bf16 v[176:179], v[206:207], v[134:135], v[176:179]
  v_lshlrev_b32 v4, 4, v1
  v_mov_b32 v37, 0
L_jw:
  ds_read_b32 v38, v37 offset:18960
  s_waitcnt lgkmcnt(0)
  v_readfirstlane_b32 s77, v38
  s_sub_u32 s77, s77, 1
  s_cbranch_scc1 L_jw
  s_mul_i32 s74, s77, 9363
  s_lshr_b32 s74, s74, 16
  s_lshr_b32 s75, s74, 1
  s_lshl_b32 s75, s75, 9
  s_lshl_b32 s76, s32, 7
  s_add_u32 s75, s75, s76
  s_add_u32 s75, s75, 2621440
  s_lshl_b32 s74, s74, 15
  s_lshl_b32 s76, s32, 13
  s_add_u32 s74, s74, s76
  s_add_u32 s74, s74, 1572864
  s_add_u32 s76, s74, 4096
  v_and_b32 v36, 7, v1
  v_lshlrev_b32 v36, 4, v36
  s_cmp_ge_u32 s77, 224
  s_cbranch_scc1 L_nor0
  buffer_load_dwordx4 v[32:35], v36, s[12:15], s75 offen sc1
L_nor0:
  v_mov_b32 v182, v181
  s_nop 1
  v_permlane32_swap_b32 v181, v182
  s_nop 0
  v_add_f32 v181, v181, v182
  v_mov_b32 v182, v181
  s_nop 1
  v_permlane16_swap_b32 v181, v182
  s_nop 0
  v_add_f32 v181, v181, v182
  s_lshl_b32 s38, s32, 11
  v_lshl_add_u32 v182, v1, 4, s38
  v_and_b32 v183, 2, v1
  v_lshlrev_b32 v183, 2, v183
  v_lshl_add_u32 v183, s32, 4, v183
  ds_write_b128 v182, v[172:175] offset:8448
  ds_write_b128 v182, v[176:179] offset:9472
  ds_write_b64 v183, v[180:181] offset:16640
  s_lshr_b32 s38, s32, 1
  s_and_b32 s39, s32, 1
  s_lshl_b32 s40, s38, 10
  s_lshl_b32 s42, s39, 3
  s_add_u32 s40, s40, s42
  v_lshl_add_u32 v182, v1, 4, s40
  v_mov_b32 v183, s42
  s_lshr_b32 s40, s2, 2
  s_and_b32 s40, s40, 7
  s_lshl_b32 s40, s40, 1
  s_add_u32 s40, s40, s39
  s_lshr_b32 s42, s2, 5
  s_lshl_b32 s42, s42, 2
  s_and_b32 s43, s2, 3
  s_add_u32 s42, s42, s43
  s_lshl_b32 s43, s40, 5
  s_add_u32 s43, s43, s42
  s_lshl_b32 s43, s43, 4
  s_add_u32 s43, s43, 2621440
  s_lshl_b32 s40, s40, 1
  s_add_u32 s40, s40, s38
  s_lshl_b32 s40, s40, 5
  s_add_u32 s40, s40, s42
  s_lshl_b32 s40, s40, 10
  s_add_u32 s40, s40, 1572864
  v_lshlrev_b32 v4, 4, v1
  s_waitcnt lgkmcnt(0)
  s_barrier
  ds_read_b64 v[8:9], v183 offset:16640
  ds_read_b64 v[10:11], v183 offset:16656
  ds_read_b64 v[12:13], v183 offset:16672
  ds_read_b64 v[14:15], v183 offset:16688
  ds_read_b64 v[16:17], v182 offset:8448
  ds_read_b64 v[18:19], v182 offset:10496
  ds_read_b64 v[20:21], v182 offset:12544
  ds_read_b64 v[22:23], v182 offset:14592
  s_waitcnt lgkmcnt(4)
  v_max3_f32 v28, v8, v10, v12
  v_max_f32 v28, v28, v14
  v_mov_b32 v25, s33
  v_mov_b32 v27, s33
  v_mov_b32 v29, s33
  v_mov_b32 v31, s33
  v_sub_f32 v8, v8, v28
  v_mul_f32 v8, s35, v8
  v_exp_f32 v8, v8
  v_sub_f32 v10, v10, v28
  v_mul_f32 v10, s35, v10
  v_exp_f32 v10, v10
  v_sub_f32 v12, v12, v28
  v_mul_f32 v12, s35, v12
  v_exp_f32 v12, v12
  v_sub_f32 v14, v14, v28
  v_mul_f32 v14, s35, v14
  v_exp_f32 v14, v14
  s_waitcnt lgkmcnt(0)
  v_mul_f32 v24, v8, v16
  v_mul_f32 v26, v8, v17
  v_mul_f32 v30, v8, v9
  v_fmac_f32 v24, v10, v18
  v_fmac_f32 v26, v10, v19
  v_fmac_f32 v30, v10, v11
  v_fmac_f32 v24, v12, v20
  v_fmac_f32 v26, v12, v21
  v_fmac_f32 v30, v12, v13
  v_fmac_f32 v24, v14, v22
  v_fmac_f32 v26, v14, v23
  v_fmac_f32 v30, v14, v15
  buffer_store_dwordx4 v[24:27], v4, s[12:15], s40 offen sc1
  s_cmp_lg_u32 s38, 0
  s_cbranch_scc1 L_noml
  s_mov_b64 exec, 1
  buffer_store_dwordx4 v[28:31], v4, s[12:15], s43 offen sc1
  s_mov_b64 exec, -1
  s_waitcnt vmcnt(2)
  s_branch L_ml
L_noml:
  s_waitcnt vmcnt(1)
L_ml:
  s_cmp_ge_u32 s77, 224
  s_cbranch_scc1 L_send
  s_mov_b32 s42, 0xff
  s_mov_b32 s41, 20000
  s_branch L_hint
L_chk:
  v_xor_b32 v72, s33, v41
  v_xor_b32 v80, s33, v43
  v_xor_b32 v73, s33, v45
  v_xor_b32 v81, s33, v47
  v_xor_b32 v74, s33, v49
  v_xor_b32 v82, s33, v51
  v_xor_b32 v75, s33, v53
  v_xor_b32 v83, s33, v55
  v_xor_b32 v76, s33, v57
  v_xor_b32 v84, s33, v59
  v_xor_b32 v77, s33, v61
  v_xor_b32 v85, s33, v63
  v_xor_b32 v78, s33, v65
  v_xor_b32 v86, s33, v67
  v_xor_b32 v79, s33, v69
  v_xor_b32 v87, s33, v71
  v_or_b32 v72, v72, v80
  v_or_b32 v73, v73, v81
  v_or_b32 v74, v74, v82
  v_or_b32 v75, v75, v83
  v_or_b32 v76, v76, v84
  v_or_b32 v77, v77, v85
  v_or_b32 v78, v78, v86
  v_or_b32 v79, v79, v87
  v_cmp_ne_u32 s[48:49], 0, v72
  v_cmp_ne_u32 s[50:51], 0, v73
  v_cmp_ne_u32 s[52:53], 0, v74
  v_cmp_ne_u32 s[54:55], 0, v75
  v_cmp_ne_u32 s[56:57], 0, v76
  v_cmp_ne_u32 s[58:59], 0, v77
  v_cmp_ne_u32 s[60:61], 0, v78
  v_cmp_ne_u32 s[62:63], 0, v79
  s_mov_b32 s42, 0
  s_cmp_lg_u64 s[62:63], 0
  s_addc_u32 s42, s42, s42
  s_cmp_lg_u64 s[60:61], 0
  s_addc_u32 s42, s42, s42
  s_cmp_lg_u64 s[58:59], 0
  s_addc_u32 s42, s42, s42
  s_cmp_lg_u64 s[56:57], 0
  s_addc_u32 s42, s42, s42
  s_cmp_lg_u64 s[54:55], 0
  s_addc_u32 s42, s42, s42
  s_cmp_lg_u64 s[52:53], 0
  s_addc_u32 s42, s42, s42
  s_cmp_lg_u64 s[50:51], 0
  s_addc_u32 s42, s42, s42
  s_cmp_lg_u64 s[48:49], 0
  s_addc_u32 s42, s42, s42
L_hint:
  v_cmp_ne_u32 s[48:49], s33, v33
  v_cmp_ne_u32 vcc, s33, v35
  s_or_b64 vcc, vcc, s[48:49]
  s_bcnt1_i32_b64 s43, vcc
  s_or_b32 s38, s43, s42
  s_cbranch_scc0 L_got
  s_sub_u32 s41, s41, 1
  s_cbranch_scc1 L_got
  s_cmp_le_u32 s43, 16
  s_cbranch_scc1 L_rnd
  s_sleep 8
  buffer_load_dwordx4 v[32:35], v36, s[12:15], s75 offen sc1
  s_waitcnt vmcnt(0)
  s_branch L_hint
L_rnd:
  s_bitcmp0_b32 s42, 0
  s_cbranch_scc1 L_sk_3
  buffer_load_dwordx4 v[40:43], v4, s[12:15], s74 offen offset:0 sc1
L_sk_3:
  s_bitcmp0_b32 s42, 1
  s_cbranch_scc1 L_sk_4
  buffer_load_dwordx4 v[44:47], v4, s[12:15], s74 offen offset:1024 sc1
L_sk_4:
  s_bitcmp0_b32 s42, 2
  s_cbranch_scc1 L_sk_5
  buffer_load_dwordx4 v[48:51], v4, s[12:15], s74 offen offset:2048 sc1
L_sk_5:
  s_bitcmp0_b32 s42, 3
  s_cbranch_scc1 L_sk_6
  buffer_load_dwordx4 v[52:55], v4, s[12:15], s74 offen offset:3072 sc1
L_sk_6:
  s_bitcmp0_b32 s42, 4
  s_cbranch_scc1 L_sk_7
  buffer_load_dwordx4 v[56:59], v4, s[12:15], s76 offen offset:0 sc1
L_sk_7:
  s_bitcmp0_b32 s42, 5
  s_cbranch_scc1 L_sk_8
  buffer_load_dwordx4 v[60:63], v4, s[12:15], s76 offen offset:1024 sc1
L_sk_8:
  s_bitcmp0_b32 s42, 6
  s_cbranch_scc1 L_sk_9
  buffer_load_dwordx4 v[64:67], v4, s[12:15], s76 offen offset:2048 sc1
L_sk_9:
  s_bitcmp0_b32 s42, 7
  s_cbranch_scc1 L_sk_10
  buffer_load_dwordx4 v[68:71], v4, s[12:15], s76 offen offset:3072 sc1
L_sk_10:
  buffer_load_dwordx4 v[32:35], v36, s[12:15], s75 offen sc1
  s_waitcnt vmcnt(0)
  s_branch L_chk
L_got:
  v_max_f32_dpp v12, v32, v32 quad_perm:[1,0,3,2] row_mask:0xf bank_mask:0xf
  s_nop 1
  v_max_f32_dpp v12, v12, v12 quad_perm:[2,3,0,1] row_mask:0xf bank_mask:0xf
  v_sub_f32 v12, v32, v12
  v_mul_f32 v12, s35, v12
  v_exp_f32 v12, v12
  s_nop 0
  v_mul_f32 v13, v12, v34
  s_nop 1
  v_add_f32_dpp v13, v13, v13 quad_perm:[1,0,3,2] row_mask:0xf bank_mask:0xf
  s_nop 1
  v_add_f32_dpp v13, v13, v13 quad_perm:[2,3,0,1] row_mask:0xf bank_mask:0xf
  v_rcp_f32 v13, v13
  s_nop 0
  v_mul_f32 v12, v12, v13
  s_nop 0
  v_readlane_b32 s48, v12, 0
  v_readlane_b32 s49, v12, 1
  v_readlane_b32 s50, v12, 2
  v_readlane_b32 s51, v12, 3
  v_readlane_b32 s52, v12, 4
  v_readlane_b32 s53, v12, 5
  v_readlane_b32 s54, v12, 6
  v_readlane_b32 s55, v12, 7
  s_nop 1
  v_mul_f32 v16, s48, v40
  v_mul_f32 v17, s48, v42
  v_fmac_f32 v16, s49, v44
  v_fmac_f32 v17, s49, v46
  v_fmac_f32 v16, s50, v48
  v_fmac_f32 v17, s50, v50
  v_fmac_f32 v16, s51, v52
  v_fmac_f32 v17, s51, v54
  v_mul_f32 v18, s52, v56
  v_mul_f32 v19, s52, v58
  v_fmac_f32 v18, s53, v60
  v_fmac_f32 v19, s53, v62
  v_fmac_f32 v18, s54, v64
  v_fmac_f32 v19, s54, v66
  v_fmac_f32 v18, s55, v68
  v_fmac_f32 v19, s55, v70
  s_mul_i32 s38, s32, 544
  v_lshl_add_u32 v5, v1, 2, s38
  v_cvt_pk_bf16_f32 v16, v16, v17
  v_cvt_pk_bf16_f32 v18, v18, v19
  ds_write_b32 v5, v16 offset:16704
  ds_write_b32 v5, v18 offset:16976
  s_waitcnt lgkmcnt(0)
  s_barrier
L_send:
  s_endpgm
L_helper:
  s_setprio 3
  s_mov_b32 s44, s16
  s_mov_b32 s45, s17
  s_mov_b32 s46, 7168
  s_mov_b32 s47, 0x20000
  s_mul_i32 s38, s3, 1792
  v_lshl_add_u32 v182, v1, 4, s38
  v_mov_b32 v192, 0
  v_mov_b32 v193, 0
  v_mov_b32 v194, 0
  v_mov_b32 v195, 0
  v_mov_b32 v196, 0
  v_mov_b32 v197, 0
  v_mov_b32 v198, 0
  v_mov_b32 v199, 0
  s_mov_b32 exec_hi, 0xffffff
  buffer_load_dwordx4 v[192:195], v182, s[44:47], 0 offen
  buffer_load_dwordx4 v[196:199], v182, s[44:47], 0 offen offset:896
  s_mov_b32 exec_hi, -1
  s_mov_b32 s4, s22
  s_mov_b32 s5, s23
  s_mov_b32 s6, 3670016
  s_mov_b32 s7, 0x20000
  s_lshr_b32 s73, s2, 5
  s_lshl_b32 s73, s73, 5
  s_and_b32 s38, s2, 7
  s_lshl_b32 s38, s38, 2
  s_add_u32 s73, s73, s38
  s_bfe_u32 s38, s2, 0x20003
  s_add_u32 s73, s73, s38
  s_lshl_b32 s38, s73, 5
  v_and_b32 v3, 1, v1
  v_lshl_add_u32 v3, v3, 4, s38
  v_lshrrev_b32 v2, 1, v1
  v_lshl_add_u32 v2, v2, 13, v3
  s_lshl_b32 s38, s3, 10
  s_add_u32 m0, s38, 35840
  s_lshl_b32 s38, s3, 18
  buffer_load_dwordx4 v2, s[4:7], s38 offen nt lds
  s_add_u32 m0, m0, 4096
  s_add_u32 s38, s38, 1048576
  buffer_load_dwordx4 v2, s[4:7], s38 offen nt lds
  s_add_u32 m0, m0, 4096
  s_add_u32 s38, s38, 1048576
  buffer_load_dwordx4 v2, s[4:7], s38 offen nt lds
  s_add_u32 m0, m0, 4096
  s_add_u32 s38, s38, 1048576
  s_cmp_ge_u32 s3, 2
  s_cbranch_scc1 L_wq3
  buffer_load_dwordx4 v2, s[4:7], s38 offen nt lds
  s_add_u32 m0, m0, 4096
  s_add_u32 s38, s38, 1048576
L_wq3:
  s_barrier
  s_mul_i32 s38, s3, 1824
  v_lshl_add_u32 v183, v1, 4, s38
  v_and_b32 v4, 15, v1
  v_lshrrev_b32 v5, 4, v1
  s_mov_b32 s54, 0
  s_mov_b32 s55, -1
  s_mov_b32 s56, 0xaaaaaaaa
  s_mov_b32 s57, 0xaaaaaaaa
  v_lshlrev_b32 v64, 8, v5
  v_lshl_add_u32 v64, v4, 3, v64
  v_lshrrev_b32 v7, 2, v4
  v_lshlrev_b32 v65, 10, v5
  v_lshl_add_u32 v65, v7, 7, v65
  v_and_b32 v7, 3, v4
  v_lshl_add_u32 v65, v7, 3, v65
  v_and_b32 v7, 7, v4
  v_mul_u32_u24 v66, 912, v7
  v_lshl_add_u32 v66, v5, 4, v66
  v_and_b32 v6, 1, v5
  v_lshlrev_b32 v6, 2, v6
  v_and_b32 v7, 2, v5
  v_add_u32 v6, v6, v7
  v_and_b32 v7, 1, v4
  v_add_u32 v67, v6, v7
  v_lshrrev_b32 v7, 1, v4
  v_lshlrev_b32 v68, 3, v7
  v_lshl_add_u32 v69, v67, 6, v68
  v_lshlrev_b32 v70, 4, v1
  s_lshl_b32 s38, s73, 9
  s_add_u32 s38, s38, 4096
  s_bfe_u32 s39, s2, 0x30002
  s_lshl_b32 s39, s39, 14
  s_lshr_b32 s40, s2, 5
  s_lshl_b32 s40, s40, 6
  s_add_u32 s39, s39, s40
  s_add_u32 s39, s39, 4096
  s_add_u32 s42, s39, 8192
  v_lshrrev_b32 v71, 2, v1
  v_lshlrev_b32 v71, 9, v71
  v_and_b32 v7, 3, v1
  v_lshl_add_u32 v71, v7, 4, v71
  s_waitcnt vmcnt(3)
  v_lshlrev_b32 v8, 16, v192
  v_and_b32 v9, 0xffff0000, v192
  v_lshlrev_b32 v10, 16, v193
  v_and_b32 v11, 0xffff0000, v193
  v_lshlrev_b32 v12, 16, v194
  v_and_b32 v13, 0xffff0000, v194
  v_lshlrev_b32 v14, 16, v195
  v_and_b32 v15, 0xffff0000, v195
  v_lshlrev_b32 v16, 16, v196
  v_and_b32 v17, 0xffff0000, v196
  v_lshlrev_b32 v18, 16, v197
  v_and_b32 v19, 0xffff0000, v197
  v_lshlrev_b32 v20, 16, v198
  v_and_b32 v21, 0xffff0000, v198
  v_lshlrev_b32 v22, 16, v199
  v_and_b32 v23, 0xffff0000, v199
  v_add_f32 v24, v8, v9
  v_add_f32 v25, v16, v17
  v_add_f32 v24, v24, v10
  v_add_f32 v25, v25, v18
  v_add_f32 v24, v24, v11
  v_add_f32 v25, v25, v19
  v_add_f32 v24, v24, v12
  v_add_f32 v25, v25, v20
  v_add_f32 v24, v24, v13
  v_add_f32 v25, v25, v21
  v_add_f32 v24, v24, v14
  v_add_f32 v25, v25, v22
  v_add_f32 v24, v24, v15
  v_add_f32 v25, v25, v23
  s_nop 0
  v_add_f32_dpp v24, v24, v24 quad_perm:[1,0,3,2] row_mask:0xf bank_mask:0xf
  v_add_f32_dpp v25, v25, v25 quad_perm:[1,0,3,2] row_mask:0xf bank_mask:0xf
  s_nop 0
  v_add_f32_dpp v24, v24, v24 quad_perm:[2,3,0,1] row_mask:0xf bank_mask:0xf
  v_add_f32_dpp v25, v25, v25 quad_perm:[2,3,0,1] row_mask:0xf bank_mask:0xf
  s_nop 0
  v_add_f32_dpp v24, v24, v24 row_ror:4 row_mask:0xf bank_mask:0xf
  v_add_f32_dpp v25, v25, v25 row_ror:4 row_mask:0xf bank_mask:0xf
  s_nop 0
  v_add_f32_dpp v24, v24, v24 row_ror:8 row_mask:0xf bank_mask:0xf
  v_add_f32_dpp v25, v25, v25 row_ror:8 row_mask:0xf bank_mask:0xf
  v_mov_b32 v32, v24
  v_mov_b32 v33, v25
  s_nop 0
  v_permlane16_swap_b32 v24, v32
  v_permlane16_swap_b32 v25, v33
  v_add_f32 v24, v24, v32
  v_add_f32 v25, v25, v33
  v_mov_b32 v32, v24
  v_mov_b32 v33, v25
  s_nop 0
  v_permlane32_swap_b32 v24, v32
  v_permlane32_swap_b32 v25, v33
  v_add_f32 v24, v24, v32
  v_add_f32 v25, v25, v33
  v_mul_f32 v24, 0x3b124925, v24
  v_mul_f32 v25, 0x3b124925, v25
  v_mov_b32 v26, 0
  v_mov_b32 v27, 0
  s_mov_b32 exec_hi, 0xffffff
  v_sub_f32 v28, v8, v24
  v_fmac_f32 v26, v28, v28
  v_sub_f32 v28, v9, v24
  v_fmac_f32 v26, v28, v28
  v_sub_f32 v28, v10, v24
  v_fmac_f32 v26, v28, v28
  v_sub_f32 v28, v11, v24
  v_fmac_f32 v26, v28, v28
  v_sub_f32 v28, v12, v24
  v_fmac_f32 v26, v28, v28
  v_sub_f32 v28, v13, v24
  v_fmac_f32 v26, v28, v28
  v_sub_f32 v28, v14, v24
  v_fmac_f32 v26, v28, v28
  v_sub_f32 v28, v15, v24
  v_fmac_f32 v26, v28, v28
  v_sub_f32 v28, v16, v25
  v_fmac_f32 v27, v28, v28
  v_sub_f32 v28, v17, v25
  v_fmac_f32 v27, v28, v28
  v_sub_f32 v28, v18, v25
  v_fmac_f32 v27, v28, v28
  v_sub_f32 v28, v19, v25
  v_fmac_f32 v27, v28, v28
  v_sub_f32 v28, v20, v25
  v_fmac_f32 v27, v28, v28
  v_sub_f32 v28, v21, v25
  v_fmac_f32 v27, v28, v28
  v_sub_f32 v28, v22, v25
  v_fmac_f32 v27, v28, v28
  v_sub_f32 v28, v23, v25
  v_fmac_f32 v27, v28, v28
  s_mov_b32 exec_hi, -1
  s_nop 0
  s_nop 0
  v_add_f32_dpp v26, v26, v26 quad_perm:[1,0,3,2] row_mask:0xf bank_mask:0xf
  v_add_f32_dpp v27, v27, v27 quad_perm:[1,0,3,2] row_mask:0xf bank_mask:0xf
  s_nop 0
  v_add_f32_dpp v26, v26, v26 quad_perm:[2,3,0,1] row_mask:0xf bank_mask:0xf
  v_add_f32_dpp v27, v27, v27 quad_perm:[2,3,0,1] row_mask:0xf bank_mask:0xf
  s_nop 0
  v_add_f32_dpp v26, v26, v26 row_ror:4 row_mask:0xf bank_mask:0xf
  v_add_f32_dpp v27, v27, v27 row_ror:4 row_mask:0xf bank_mask:0xf
  s_nop 0
  v_add_f32_dpp v26, v26, v26 row_ror:8 row_mask:0xf bank_mask:0xf
  v_add_f32_dpp v27, v27, v27 row_ror:8 row_mask:0xf bank_mask:0xf
  v_mov_b32 v32, v26
  v_mov_b32 v33, v27
  s_nop 0
  v_permlane16_swap_b32 v26, v32
  v_permlane16_swap_b32 v27, v33
  v_add_f32 v26, v26, v32
  v_add_f32 v27, v27, v33
  v_mov_b32 v32, v26
  v_mov_b32 v33, v27
  s_nop 0
  v_permlane32_swap_b32 v26, v32
  v_permlane32_swap_b32 v27, v33
  v_add_f32 v26, v26, v32
  v_add_f32 v27, v27, v33
  v_mul_f32 v26, 0x3b124925, v26
  v_mul_f32 v27, 0x3b124925, v27
  v_cvt_pk_bf16_f32 v25, v24, v25
  v_lshlrev_b32 v24, 16, v25
  v_and_b32 v25, 0xffff0000, v25
  v_cvt_pk_bf16_f32 v27, v26, v27
  v_lshlrev_b32 v26, 16, v27
  v_and_b32 v27, 0xffff0000, v27
  v_add_f32 v26, 0x3727c5ac, v26
  v_add_f32 v27, 0x3727c5ac, v27
  v_cvt_pk_bf16_f32 v27, v26, v27
  v_lshlrev_b32 v26, 16, v27
  v_and_b32 v27, 0xffff0000, v27
  v_sqrt_f32 v26, v26
  v_sqrt_f32 v27, v27
  s_nop 0
  v_cvt_pk_bf16_f32 v27, v26, v27
  v_lshlrev_b32 v26, 16, v27
  v_and_b32 v27, 0xffff0000, v27
  v_rcp_f32 v28, v26
  v_rcp_f32 v29, v27
  v_sub_f32 v8, v8, v24
  v_sub_f32 v9, v9, v24
  v_sub_f32 v10, v10, v24
  v_sub_f32 v11, v11, v24
  v_sub_f32 v12, v12, v24
  v_sub_f32 v13, v13, v24
  v_sub_f32 v14, v14, v24
  v_sub_f32 v15, v15, v24
  v_sub_f32 v16, v16, v25
  v_sub_f32 v17, v17, v25
  v_sub_f32 v18, v18, v25
  v_sub_f32 v19, v19, v25
  v_sub_f32 v20, v20, v25
  v_sub_f32 v21, v21, v25
  v_sub_f32 v22, v22, v25
  v_sub_f32 v23, v23, v25
  v_cvt_pk_bf16_f32 v9, v8, v9
  v_lshlrev_b32 v8, 16, v9
  v_and_b32 v9, 0xffff0000, v9
  v_cvt_pk_bf16_f32 v11, v10, v11
  v_lshlrev_b32 v10, 16, v11
  v_and_b32 v11, 0xffff0000, v11
  v_cvt_pk_bf16_f32 v13, v12, v13
  v_lshlrev_b32 v12, 16, v13
  v_and_b32 v13, 0xffff0000, v13
  v_cvt_pk_bf16_f32 v15, v14, v15
  v_lshlrev_b32 v14, 16, v15
  v_and_b32 v15, 0xffff0000, v15
  v_cvt_pk_bf16_f32 v17, v16, v17
  v_lshlrev_b32 v16, 16, v17
  v_and_b32 v17, 0xffff0000, v17
  v_cvt_pk_bf16_f32 v19, v18, v19
  v_lshlrev_b32 v18, 16, v19
  v_and_b32 v19, 0xffff0000, v19
  v_cvt_pk_bf16_f32 v21, v20, v21
  v_lshlrev_b32 v20, 16, v21
  v_and_b32 v21, 0xffff0000, v21
  v_cvt_pk_bf16_f32 v23, v22, v23
  v_lshlrev_b32 v22, 16, v23
  v_and_b32 v23, 0xffff0000, v23
  v_mul_f32 v30, v8, v28
  v_fma_f32 v8, -v30, v26, v8
  v_fma_f32 v8, v8, v28, v30
  v_mul_f32 v30, v9, v28
  v_fma_f32 v9, -v30, v26, v9
  v_fma_f32 v9, v9, v28, v30
  v_mul_f32 v30, v10, v28
  v_fma_f32 v10, -v30, v26, v10
  v_fma_f32 v10, v10, v28, v30
  v_mul_f32 v30, v11, v28
  v_fma_f32 v11, -v30, v26, v11
  v_fma_f32 v11, v11, v28, v30
  v_mul_f32 v30, v12, v28
  v_fma_f32 v12, -v30, v26, v12
  v_fma_f32 v12, v12, v28, v30
  v_mul_f32 v30, v13, v28
  v_fma_f32 v13, -v30, v26, v13
  v_fma_f32 v13, v13, v28, v30
  v_mul_f32 v30, v14, v28
  v_fma_f32 v14, -v30, v26, v14
  v_fma_f32 v14, v14, v28, v30
  v_mul_f32 v30, v15, v28
  v_fma_f32 v15, -v30, v26, v15
  v_fma_f32 v15, v15, v28, v30
  v_mul_f32 v30, v16, v29
  v_fma_f32 v16, -v30, v27, v16
  v_fma_f32 v16, v16, v29, v30
  v_mul_f32 v30, v17, v29
  v_fma_f32 v17, -v30, v27, v17
  v_fma_f32 v17, v17, v29, v30
  v_mul_f32 v30, v18, v29
  v_fma_f32 v18, -v30, v27, v18
  v_fma_f32 v18, v18, v29, v30
  v_mul_f32 v30, v19, v29
  v_fma_f32 v19, -v30, v27, v19
  v_fma_f32 v19, v19, v29, v30
  v_mul_f32 v30, v20, v29
  v_fma_f32 v20, -v30, v27, v20
  v_fma_f32 v20, v20, v29, v30
  v_mul_f32 v30, v21, v29
  v_fma_f32 v21, -v30, v27, v21
  v_fma_f32 v21, v21, v29, v30
  v_mul_f32 v30, v22, v29
  v_fma_f32 v22, -v30, v27, v22
  v_fma_f32 v22, v22, v29, v30
  v_mul_f32 v30, v23, v29
  v_fma_f32 v23, -v30, v27, v23
  v_fma_f32 v23, v23, v29, v30
  v_cvt_pk_bf16_f32 v192, v8, v9
  v_cvt_pk_bf16_f32 v193, v10, v11
  v_cvt_pk_bf16_f32 v194, v12, v13
  v_cvt_pk_bf16_f32 v195, v14, v15
  v_cvt_pk_bf16_f32 v196, v16, v17
  v_cvt_pk_bf16_f32 v197, v18, v19
  v_cvt_pk_bf16_f32 v198, v20, v21
  v_cvt_pk_bf16_f32 v199, v22, v23
  s_mov_b32 exec_hi, 0xffffff
  ds_write_b128 v183, v[192:195] offset:0
  ds_write_b128 v183, v[196:199] offset:912
  s_mov_b32 exec_hi, -1
  s_waitcnt vmcnt(0)
  s_waitcnt vmcnt(0) lgkmcnt(0)
  v_mov_b32 v6, 0
  v_mov_b32 v7, 1
  s_mov_b64 exec, 1
  ds_add_u32 v6, v7 offset:18948
  s_mov_b64 exec, -1
  s_cmp_lg_u32 s3, 0
  s_cbranch_scc1 L_b1
  v_mov_b32 v6, 0
L_lw_11:
  ds_read_b32 v7, v6 offset:18948
  s_waitcnt lgkmcnt(0)
  s_add_u32 s33, s72, 0x9e3779b9
  v_readfirstlane_b32 s40, v7
  s_cmp_lt_u32 s40, 4
  s_cbranch_scc1 L_lw_11
  ds_read_b128 v[8:11], v66 offset:0
  ds_read_b128 v[12:15], v66 offset:64
  ds_read_b128 v[16:19], v66 offset:128
  ds_read_b128 v[20:23], v66 offset:192
  ds_read_b128 v[24:27], v66 offset:256
  ds_read_b128 v[28:31], v66 offset:320
  ds_read_b128 v[32:35], v66 offset:384
  ds_read_b128 v[36:39], v66 offset:448
  ds_read_b128 v[40:43], v66 offset:512
  ds_read_b128 v[44:47], v66 offset:576
  ds_read_b128 v[48:51], v66 offset:640
  ds_read_b128 v[52:55], v66 offset:704
  ds_read_b128 v[56:59], v66 offset:768
  ds_read_b128 v[60:63], v66 offset:832
  ds_read_b64_tr_b16 v[136:137], v64 offset:35840
  ds_read_b64_tr_b16 v[138:139], v64 offset:35968
  ds_read_b64_tr_b16 v[140:141], v64 offset:36864
  ds_read_b64_tr_b16 v[142:143], v64 offset:36992
  ds_read_b64_tr_b16 v[144:145], v64 offset:37888
  ds_read_b64_tr_b16 v[146:147], v64 offset:38016
  ds_read_b64_tr_b16 v[148:149], v64 offset:38912
  ds_read_b64_tr_b16 v[150:151], v64 offset:39040
  ds_read_b64_tr_b16 v[152:153], v64 offset:39936
  ds_read_b64_tr_b16 v[154:155], v64 offset:40064
  ds_read_b64_tr_b16 v[156:157], v64 offset:40960
  ds_read_b64_tr_b16 v[158:159], v64 offset:41088
  ds_read_b64_tr_b16 v[160:161], v64 offset:41984
  ds_read_b64_tr_b16 v[162:163], v64 offset:42112
  s_waitcnt lgkmcnt(0)
  v_mfma_f32_16x16x32_bf16 v[112:115], v[8:11], v[136:139], 0
  v_mfma_f32_16x16x32_bf16 v[112:115], v[12:15], v[140:143], v[112:115]
  v_mfma_f32_16x16x32_bf16 v[112:115], v[16:19], v[144:147], v[112:115]
  v_mfma_f32_16x16x32_bf16 v[112:115], v[20:23], v[148:151], v[112:115]
  v_mfma_f32_16x16x32_bf16 v[112:115], v[24:27], v[152:155], v[112:115]
  v_mfma_f32_16x16x32_bf16 v[112:115], v[28:31], v[156:159], v[112:115]
  v_mfma_f32_16x16x32_bf16 v[112:115], v[32:35], v[160:163], v[112:115]
  ds_read_b64_tr_b16 v[164:165], v64 offset:43008
  ds_read_b64_tr_b16 v[166:167], v64 offset:43136
  ds_read_b64_tr_b16 v[168:169], v64 offset:44032
  ds_read_b64_tr_b16 v[170:171], v64 offset:44160
  ds_read_b64_tr_b16 v[172:173], v64 offset:45056
  ds_read_b64_tr_b16 v[174:175], v64 offset:45184
  ds_read_b64_tr_b16 v[176:177], v64 offset:46080
  ds_read_b64_tr_b16 v[178:179], v64 offset:46208
  ds_read_b64_tr_b16 v[180:181], v64 offset:47104
  ds_read_b64_tr_b16 v[182:183], v64 offset:47232
  ds_read_b64_tr_b16 v[184:185], v64 offset:48128
  ds_read_b64_tr_b16 v[186:187], v64 offset:48256
  ds_read_b64_tr_b16 v[188:189], v64 offset:49152
  ds_read_b64_tr_b16 v[190:191], v64 offset:49280
  s_waitcnt lgkmcnt(0)
  v_mfma_f32_16x16x32_bf16 v[112:115], v[36:39], v[164:167], v[112:115]
  v_mfma_f32_16x16x32_bf16 v[112:115], v[40:43], v[168:171], v[112:115]
  v_mfma_f32_16x16x32_bf16 v[112:115], v[44:47], v[172:175], v[112:115]
  v_mfma_f32_16x16x32_bf16 v[112:115], v[48:51], v[176:179], v[112:115]
  v_mfma_f32_16x16x32_bf16 v[112:115], v[52:55], v[180:183], v[112:115]
  v_mfma_f32_16x16x32_bf16 v[112:115], v[56:59], v[184:187], v[112:115]
  v_mfma_f32_16x16x32_bf16 v[112:115], v[60:63], v[188:191], v[112:115]
  v_mov_b32 v73, s33
  s_nop 6
  v_cndmask_b32 v104, v112, v114, s[54:55]
  v_cndmask_b32 v105, v113, v115, s[54:55]
  s_nop 1
  v_mov_b32_dpp v106, v104 quad_perm:[1,0,3,2] row_mask:0xf bank_mask:0xf
  v_mov_b32_dpp v107, v105 quad_perm:[1,0,3,2] row_mask:0xf bank_mask:0xf
  v_cndmask_b32 v117, v106, v105, s[56:57]
  v_cndmask_b32 v116, v104, v107, s[56:57]
  v_cvt_pk_bf16_f32 v72, v116, v117
  buffer_store_dwordx2 v[72:73], v69, s[12:15], s38 offen sc1
  s_mov_b32 s41, 20000
L_q_12:
  buffer_load_dwordx4 v[76:79], v71, s[12:15], s39 offen sc1
  buffer_load_dwordx4 v[80:83], v71, s[12:15], s42 offen sc1
  s_waitcnt vmcnt(0)
  v_xor_b32 v104, s33, v77
  v_xor_b32 v105, s33, v79
  v_or_b32 v104, v104, v105
  v_xor_b32 v105, s33, v81
  v_or_b32 v104, v104, v105
  v_xor_b32 v105, s33, v83
  v_or_b32 v104, v104, v105
  v_cmp_ne_u32 vcc, 0, v104
  s_nop 4
  s_cbranch_vccz L_dn_13
  s_sub_u32 s41, s41, 1
  s_cmp_eq_u32 s41, 0
  s_cbranch_scc1 L_dn_13
  s_sleep 0
  s_branch L_q_12
L_dn_13:
  v_lshlrev_b32 v6, 3, v1
  v_add_u32 v6, 7424, v6
  ds_write2_b32 v6, v76, v78 offset0:0 offset1:1
  ds_write2_b32 v6, v80, v82 offset0:128 offset1:129
  s_waitcnt lgkmcnt(0)
L_b1:
  s_barrier
  s_cmp_lg_u32 s3, 0
  s_cbranch_scc1 L_getjob
  s_mov_b32 s60, s68
  s_mov_b32 s61, s69
  s_mov_b32 s62, 256
  s_mov_b32 s63, 0x20000
  v_mov_b32 v6, 0
L_lw_14:
  s_sleep 16
  ds_read_b32 v7, v6 offset:18944
  s_waitcnt lgkmcnt(0)
  v_readfirstlane_b32 s40, v7
  s_cmp_lt_u32 s40, 180
  s_cbranch_scc1 L_lw_14
  v_mov_b32 v7, 1
  s_mov_b64 exec, 1
  buffer_atomic_add v7, v6, s[60:63], 0 offen sc0 sc1
  s_waitcnt vmcnt(0)
  v_and_b32 v7, 0xff, v7
  v_add_u32 v7, 1, v7
  ds_write_b32 v6, v7 offset:18952
  s_mov_b64 exec, -1
L_getjob:
  v_mov_b32 v6, 0
L_lw_15:
  s_sleep 16
  ds_read_b32 v7, v6 offset:18952
  s_waitcnt lgkmcnt(0)
  v_readfirstlane_b32 s40, v7
  s_cmp_eq_u32 s40, 0
  s_cbranch_scc1 L_lw_15
  s_sub_u32 s58, s40, 1
  s_cmp_ge_u32 s58, 42
  s_cbranch_scc1 L_nojob
  s_lshl_b32 s59, s58, 7
  s_add_u32 s59, s59, 163840
  s_cmp_ge_u32 s58, 28
  s_cbranch_scc1 L_j3
  v_lshrrev_b32 v2, 3, v1
  v_mul_u32_u24 v2, 3584, v2
  v_and_b32 v7, 7, v1
  v_lshl_add_u32 v2, v7, 4, v2
  s_lshl_b32 s42, s58, 7
  s_mov_b32 s4, s28
  s_mov_b32 s5, s29
  s_mov_b32 s6, 1605632
  s_mov_b32 s7, 0x20000
  s_mov_b32 s44, s30
  s_mov_b32 s45, s31
  s_mov_b32 s46, 1605632
  s_mov_b32 s47, 0x20000
  s_lshl_b32 s40, s3, 11
  s_add_u32 m0, s40, 35840
  s_mul_i32 s40, s3, 57344
  s_add_u32 s40, s40, s42
  s_mov_b32 s41, 7
L_dma_16:
  buffer_load_dwordx4 v2, s[4:7], s40 offen nt lds
  s_add_u32 m0, m0, 1024
  s_add_u32 s40, s40, 28672
  buffer_load_dwordx4 v2, s[4:7], s40 offen nt lds
  s_add_u32 m0, m0, 7168
  s_add_u32 s40, s40, 200704
  s_sub_u32 s41, s41, 1
  s_cmp_lg_u32 s41, 0
  s_cbranch_scc1 L_dma_16
  s_lshl_b32 s40, s3, 11
  s_add_u32 m0, s40, 93184
  s_mul_i32 s40, s3, 57344
  s_add_u32 s40, s40, s42
  s_mov_b32 s41, 7
L_dma_17:
  buffer_load_dwordx4 v2, s[44:47], s40 offen nt lds
  s_add_u32 m0, m0, 1024
  s_add_u32 s40, s40, 28672
  buffer_load_dwordx4 v2, s[44:47], s40 offen nt lds
  s_add_u32 m0, m0, 7168
  s_add_u32 s40, s40, 200704
  s_sub_u32 s41, s41, 1
  s_cmp_lg_u32 s41, 0
  s_cbranch_scc1 L_dma_17
  s_waitcnt vmcnt(0) lgkmcnt(0)
  v_mov_b32 v6, 0
  v_mov_b32 v7, 1
  s_mov_b64 exec, 1
  ds_add_u32 v6, v7 offset:18956
  s_mov_b64 exec, -1
  s_cmp_lg_u32 s3, 0
  s_cbranch_scc1 L_wo
  v_mov_b32 v6, 0
L_lw_18:
  s_sleep 4
  ds_read_b32 v7, v6 offset:18956
  s_waitcnt lgkmcnt(0)
  v_readfirstlane_b32 s40, v7
  s_cmp_lt_u32 s40, 4
  s_cbranch_scc1 L_lw_18
  v_add_u32 v71, 35840, v65
  s_waitcnt vmcnt(0)
  ds_read_b64_tr_b16 v[136:137], v71 offset:0
  ds_read_b64_tr_b16 v[138:139], v71 offset:512
  ds_read_b64_tr_b16 v[140:141], v71 offset:32
  ds_read_b64_tr_b16 v[142:143], v71 offset:544
  ds_read_b64_tr_b16 v[144:145], v71 offset:64
  ds_read_b64_tr_b16 v[146:147], v71 offset:576
  ds_read_b64_tr_b16 v[148:149], v71 offset:96
  ds_read_b64_tr_b16 v[150:151], v71 offset:608
  s_waitcnt lgkmcnt(0)
  v_mfma_f32_16x16x32_bf16 v[112:115], v[8:11], v[136:139], 0
  v_mfma_f32_16x16x32_bf16 v[116:119], v[8:11], v[140:143], 0
  v_mfma_f32_16x16x32_bf16 v[120:123], v[8:11], v[144:147], 0
  v_mfma_f32_16x16x32_bf16 v[124:127], v[8:11], v[148:151], 0
  ds_read_b64_tr_b16 v[152:153], v71 offset:4096
  ds_read_b64_tr_b16 v[154:155], v71 offset:4608
  ds_read_b64_tr_b16 v[156:157], v71 offset:4128
  ds_read_b64_tr_b16 v[158:159], v71 offset:4640
  ds_read_b64_tr_b16 v[160:161], v71 offset:4160
  ds_read_b64_tr_b16 v[162:163], v71 offset:4672
  ds_read_b64_tr_b16 v[164:165], v71 offset:4192
  ds_read_b64_tr_b16 v[166:167], v71 offset:4704
  s_waitcnt lgkmcnt(0)
  v_mfma_f32_16x16x32_bf16 v[112:115], v[12:15], v[152:155], v[112:115]
  v_mfma_f32_16x16x32_bf16 v[116:119], v[12:15], v[156:159], v[116:119]
  v_mfma_f32_16x16x32_bf16 v[120:123], v[12:15], v[160:163], v[120:123]
  v_mfma_f32_16x16x32_bf16 v[124:127], v[12:15], v[164:167], v[124:127]
  ds_read_b64_tr_b16 v[136:137], v71 offset:8192
  ds_read_b64_tr_b16 v[138:139], v71 offset:8704
  ds_read_b64_tr_b16 v[140:141], v71 offset:8224
  ds_read_b64_tr_b16 v[142:143], v71 offset:8736
  ds_read_b64_tr_b16 v[144:145], v71 offset:8256
  ds_read_b64_tr_b16 v[146:147], v71 offset:8768
  ds_read_b64_tr_b16 v[148:149], v71 offset:8288
  ds_read_b64_tr_b16 v[150:151], v71 offset:8800
  s_waitcnt lgkmcnt(0)
  v_mfma_f32_16x16x32_bf16 v[112:115], v[16:19], v[136:139], v[112:115]
  v_mfma_f32_16x16x32_bf16 v[116:119], v[16:19], v[140:143], v[116:119]
  v_mfma_f32_16x16x32_bf16 v[120:123], v[16:19], v[144:147], v[120:123]
  v_mfma_f32_16x16x32_bf16 v[124:127], v[16:19], v[148:151], v[124:127]
  ds_read_b64_tr_b16 v[152:153], v71 offset:12288
  ds_read_b64_tr_b16 v[154:155], v71 offset:12800
  ds_read_b64_tr_b16 v[156:157], v71 offset:12320
  ds_read_b64_tr_b16 v[158:159], v71 offset:12832
  ds_read_b64_tr_b16 v[160:161], v71 offset:12352
  ds_read_b64_tr_b16 v[162:163], v71 offset:12864
  ds_read_b64_tr_b16 v[164:165], v71 offset:12384
  ds_read_b64_tr_b16 v[166:167], v71 offset:12896
  s_waitcnt lgkmcnt(0)
  v_mfma_f32_16x16x32_bf16 v[112:115], v[20:23], v[152:155], v[112:115]
  v_mfma_f32_16x16x32_bf16 v[116:119], v[20:23], v[156:159], v[116:119]
  v_mfma_f32_16x16x32_bf16 v[120:123], v[20:23], v[160:163], v[120:123]
  v_mfma_f32_16x16x32_bf16 v[124:127], v[20:23], v[164:167], v[124:127]
  ds_read_b64_tr_b16 v[136:137], v71 offset:16384
  ds_read_b64_tr_b16 v[138:139], v71 offset:16896
  ds_read_b64_tr_b16 v[140:141], v71 offset:16416
  ds_read_b64_tr_b16 v[142:143], v71 offset:16928
  ds_read_b64_tr_b16 v[144:145], v71 offset:16448
  ds_read_b64_tr_b16 v[146:147], v71 offset:16960
  ds_read_b64_tr_b16 v[148:149], v71 offset:16480
  ds_read_b64_tr_b16 v[150:151], v71 offset:16992
  s_waitcnt lgkmcnt(0)
  v_mfma_f32_16x16x32_bf16 v[112:115], v[24:27], v[136:139], v[112:115]
  v_mfma_f32_16x16x32_bf16 v[116:119], v[24:27], v[140:143], v[116:119]
  v_mfma_f32_16x16x32_bf16 v[120:123], v[24:27], v[144:147], v[120:123]
  v_mfma_f32_16x16x32_bf16 v[124:127], v[24:27], v[148:151], v[124:127]
  ds_read_b64_tr_b16 v[152:153], v71 offset:20480
  ds_read_b64_tr_b16 v[154:155], v71 offset:20992
  ds_read_b64_tr_b16 v[156:157], v71 offset:20512
  ds_read_b64_tr_b16 v[158:159], v71 offset:21024
  ds_read_b64_tr_b16 v[160:161], v71 offset:20544
  ds_read_b64_tr_b16 v[162:163], v71 offset:21056
  ds_read_b64_tr_b16 v[164:165], v71 offset:20576
  ds_read_b64_tr_b16 v[166:167], v71 offset:21088
  s_waitcnt lgkmcnt(0)
  v_mfma_f32_16x16x32_bf16 v[112:115], v[28:31], v[152:155], v[112:115]
  v_mfma_f32_16x16x32_bf16 v[116:119], v[28:31], v[156:159], v[116:119]
  v_mfma_f32_16x16x32_bf16 v[120:123], v[28:31], v[160:163], v[120:123]
  v_mfma_f32_16x16x32_bf16 v[124:127], v[28:31], v[164:167], v[124:127]
  ds_read_b64_tr_b16 v[136:137], v71 offset:24576
  ds_read_b64_tr_b16 v[138:139], v71 offset:25088
  ds_read_b64_tr_b16 v[140:141], v71 offset:24608
  ds_read_b64_tr_b16 v[142:143], v71 offset:25120
  ds_read_b64_tr_b16 v[144:145], v71 offset:24640
  ds_read_b64_tr_b16 v[146:147], v71 offset:25152
  ds_read_b64_tr_b16 v[148:149], v71 offset:24672
  ds_read_b64_tr_b16 v[150:151], v71 offset:25184
  s_waitcnt lgkmcnt(0)
  v_mfma_f32_16x16x32_bf16 v[112:115], v[32:35], v[136:139], v[112:115]
  v_mfma_f32_16x16x32_bf16 v[116:119], v[32:35], v[140:143], v[116:119]
  v_mfma_f32_16x16x32_bf16 v[120:123], v[32:35], v[144:147], v[120:123]
  v_mfma_f32_16x16x32_bf16 v[124:127], v[32:35], v[148:151], v[124:127]
  ds_read_b64_tr_b16 v[152:153], v71 offset:28672
  ds_read_b64_tr_b16 v[154:155], v71 offset:29184
  ds_read_b64_tr_b16 v[156:157], v71 offset:28704
  ds_read_b64_tr_b16 v[158:159], v71 offset:29216
  ds_read_b64_tr_b16 v[160:161], v71 offset:28736
  ds_read_b64_tr_b16 v[162:163], v71 offset:29248
  ds_read_b64_tr_b16 v[164:165], v71 offset:28768
  ds_read_b64_tr_b16 v[166:167], v71 offset:29280
  s_waitcnt lgkmcnt(0)
  v_mfma_f32_16x16x32_bf16 v[112:115], v[36:39], v[152:155], v[112:115]
  v_mfma_f32_16x16x32_bf16 v[116:119], v[36:39], v[156:159], v[116:119]
  v_mfma_f32_16x16x32_bf16 v[120:123], v[36:39], v[160:163], v[120:123]
  v_mfma_f32_16x16x32_bf16 v[124:127], v[36:39], v[164:167], v[124:127]
  ds_read_b64_tr_b16 v[136:137], v71 offset:32768
  ds_read_b64_tr_b16 v[138:139], v71 offset:33280
  ds_read_b64_tr_b16 v[140:141], v71 offset:32800
  ds_read_b64_tr_b16 v[142:143], v71 offset:33312
  ds_read_b64_tr_b16 v[144:145], v71 offset:32832
  ds_read_b64_tr_b16 v[146:147], v71 offset:33344
  ds_read_b64_tr_b16 v[148:149], v71 offset:32864
  ds_read_b64_tr_b16 v[150:151], v71 offset:33376
  s_waitcnt lgkmcnt(0)
  v_mfma_f32_16x16x32_bf16 v[112:115], v[40:43], v[136:139], v[112:115]
  v_mfma_f32_16x16x32_bf16 v[116:119], v[40:43], v[140:143], v[116:119]
  v_mfma_f32_16x16x32_bf16 v[120:123], v[40:43], v[144:147], v[120:123]
  v_mfma_f32_16x16x32_bf16 v[124:127], v[40:43], v[148:151], v[124:127]
  ds_read_b64_tr_b16 v[152:153], v71 offset:36864
  ds_read_b64_tr_b16 v[154:155], v71 offset:37376
  ds_read_b64_tr_b16 v[156:157], v71 offset:36896
  ds_read_b64_tr_b16 v[158:159], v71 offset:37408
  ds_read_b64_tr_b16 v[160:161], v71 offset:36928
  ds_read_b64_tr_b16 v[162:163], v71 offset:37440
  ds_read_b64_tr_b16 v[164:165], v71 offset:36960
  ds_read_b64_tr_b16 v[166:167], v71 offset:37472
  s_waitcnt lgkmcnt(0)
  v_mfma_f32_16x16x32_bf16 v[112:115], v[44:47], v[152:155], v[112:115]
  v_mfma_f32_16x16x32_bf16 v[116:119], v[44:47], v[156:159], v[116:119]
  v_mfma_f32_16x16x32_bf16 v[120:123], v[44:47], v[160:163], v[120:123]
  v_mfma_f32_16x16x32_bf16 v[124:127], v[44:47], v[164:167], v[124:127]
  ds_read_b64_tr_b16 v[136:137], v71 offset:40960
  ds_read_b64_tr_b16 v[138:139], v71 offset:41472
  ds_read_b64_tr_b16 v[140:141], v71 offset:40992
  ds_read_b64_tr_b16 v[142:143], v71 offset:41504
  ds_read_b64_tr_b16 v[144:145], v71 offset:41024
  ds_read_b64_tr_b16 v[146:147], v71 offset:41536
  ds_read_b64_tr_b16 v[148:149], v71 offset:41056
  ds_read_b64_tr_b16 v[150:151], v71 offset:41568
  s_waitcnt lgkmcnt(0)
  v_mfma_f32_16x16x32_bf16 v[112:115], v[48:51], v[136:139], v[112:115]
  v_mfma_f32_16x16x32_bf16 v[116:119], v[48:51], v[140:143], v[116:119]
  v_mfma_f32_16x16x32_bf16 v[120:123], v[48:51], v[144:147], v[120:123]
  v_mfma_f32_16x16x32_bf16 v[124:127], v[48:51], v[148:151], v[124:127]
  ds_read_b64_tr_b16 v[152:153], v71 offset:45056
  ds_read_b64_tr_b16 v[154:155], v71 offset:45568
  ds_read_b64_tr_b16 v[156:157], v71 offset:45088
  ds_read_b64_tr_b16 v[158:159], v71 offset:45600
  ds_read_b64_tr_b16 v[160:161], v71 offset:45120
  ds_read_b64_tr_b16 v[162:163], v71 offset:45632
  ds_read_b64_tr_b16 v[164:165], v71 offset:45152
  ds_read_b64_tr_b16 v[166:167], v71 offset:45664
  s_waitcnt lgkmcnt(0)
  v_mfma_f32_16x16x32_bf16 v[112:115], v[52:55], v[152:155], v[112:115]
  v_mfma_f32_16x16x32_bf16 v[116:119], v[52:55], v[156:159], v[116:119]
  v_mfma_f32_16x16x32_bf16 v[120:123], v[52:55], v[160:163], v[120:123]
  v_mfma_f32_16x16x32_bf16 v[124:127], v[52:55], v[164:167], v[124:127]
  ds_read_b64_tr_b16 v[136:137], v71 offset:49152
  ds_read_b64_tr_b16 v[138:139], v71 offset:49664
  ds_read_b64_tr_b16 v[140:141], v71 offset:49184
  ds_read_b64_tr_b16 v[142:143], v71 offset:49696
  ds_read_b64_tr_b16 v[144:145], v71 offset:49216
  ds_read_b64_tr_b16 v[146:147], v71 offset:49728
  ds_read_b64_tr_b16 v[148:149], v71 offset:49248
  ds_read_b64_tr_b16 v[150:151], v71 offset:49760
  s_waitcnt lgkmcnt(0)
  v_mfma_f32_16x16x32_bf16 v[112:115], v[56:59], v[136:139], v[112:115]
  v_mfma_f32_16x16x32_bf16 v[116:119], v[56:59], v[140:143], v[116:119]
  v_mfma_f32_16x16x32_bf16 v[120:123], v[56:59], v[144:147], v[120:123]
  v_mfma_f32_16x16x32_bf16 v[124:127], v[56:59], v[148:151], v[124:127]
  ds_read_b64_tr_b16 v[152:153], v71 offset:53248
  ds_read_b64_tr_b16 v[154:155], v71 offset:53760
  ds_read_b64_tr_b16 v[156:157], v71 offset:53280
  ds_read_b64_tr_b16 v[158:159], v71 offset:53792
  ds_read_b64_tr_b16 v[160:161], v71 offset:53312
  ds_read_b64_tr_b16 v[162:163], v71 offset:53824
  ds_read_b64_tr_b16 v[164:165], v71 offset:53344
  ds_read_b64_tr_b16 v[166:167], v71 offset:53856
  s_waitcnt lgkmcnt(0)
  v_mfma_f32_16x16x32_bf16 v[112:115], v[60:63], v[152:155], v[112:115]
  v_mfma_f32_16x16x32_bf16 v[116:119], v[60:63], v[156:159], v[116:119]
  v_mfma_f32_16x16x32_bf16 v[120:123], v[60:63], v[160:163], v[120:123]
  v_mfma_f32_16x16x32_bf16 v[124:127], v[60:63], v[164:167], v[124:127]
  v_add_u32 v71, 93184, v65
  s_waitcnt vmcnt(0)
  ds_read_b64_tr_b16 v[136:137], v71 offset:0
  ds_read_b64_tr_b16 v[138:139], v71 offset:512
  ds_read_b64_tr_b16 v[140:141], v71 offset:32
  ds_read_b64_tr_b16 v[142:143], v71 offset:544
  ds_read_b64_tr_b16 v[144:145], v71 offset:64
  ds_read_b64_tr_b16 v[146:147], v71 offset:576
  ds_read_b64_tr_b16 v[148:149], v71 offset:96
  ds_read_b64_tr_b16 v[150:151], v71 offset:608
  s_waitcnt lgkmcnt(0)
  v_mfma_f32_16x16x32_bf16 v[168:171], v[8:11], v[136:139], 0
  v_mfma_f32_16x16x32_bf16 v[172:175], v[8:11], v[140:143], 0
  v_mfma_f32_16x16x32_bf16 v[176:179], v[8:11], v[144:147], 0
  v_mfma_f32_16x16x32_bf16 v[180:183], v[8:11], v[148:151], 0
  ds_read_b64_tr_b16 v[152:153], v71 offset:4096
  ds_read_b64_tr_b16 v[154:155], v71 offset:4608
  ds_read_b64_tr_b16 v[156:157], v71 offset:4128
  ds_read_b64_tr_b16 v[158:159], v71 offset:4640
  ds_read_b64_tr_b16 v[160:161], v71 offset:4160
  ds_read_b64_tr_b16 v[162:163], v71 offset:4672
  ds_read_b64_tr_b16 v[164:165], v71 offset:4192
  ds_read_b64_tr_b16 v[166:167], v71 offset:4704
  s_waitcnt lgkmcnt(0)
  v_mfma_f32_16x16x32_bf16 v[168:171], v[12:15], v[152:155], v[168:171]
  v_mfma_f32_16x16x32_bf16 v[172:175], v[12:15], v[156:159], v[172:175]
  v_mfma_f32_16x16x32_bf16 v[176:179], v[12:15], v[160:163], v[176:179]
  v_mfma_f32_16x16x32_bf16 v[180:183], v[12:15], v[164:167], v[180:183]
  ds_read_b64_tr_b16 v[136:137], v71 offset:8192
  ds_read_b64_tr_b16 v[138:139], v71 offset:8704
  ds_read_b64_tr_b16 v[140:141], v71 offset:8224
  ds_read_b64_tr_b16 v[142:143], v71 offset:8736
  ds_read_b64_tr_b16 v[144:145], v71 offset:8256
  ds_read_b64_tr_b16 v[146:147], v71 offset:8768
  ds_read_b64_tr_b16 v[148:149], v71 offset:8288
  ds_read_b64_tr_b16 v[150:151], v71 offset:8800
  s_waitcnt lgkmcnt(0)
  v_mfma_f32_16x16x32_bf16 v[168:171], v[16:19], v[136:139], v[168:171]
  v_mfma_f32_16x16x32_bf16 v[172:175], v[16:19], v[140:143], v[172:175]
  v_mfma_f32_16x16x32_bf16 v[176:179], v[16:19], v[144:147], v[176:179]
  v_mfma_f32_16x16x32_bf16 v[180:183], v[16:19], v[148:151], v[180:183]
  ds_read_b64_tr_b16 v[152:153], v71 offset:12288
  ds_read_b64_tr_b16 v[154:155], v71 offset:12800
  ds_read_b64_tr_b16 v[156:157], v71 offset:12320
  ds_read_b64_tr_b16 v[158:159], v71 offset:12832
  ds_read_b64_tr_b16 v[160:161], v71 offset:12352
  ds_read_b64_tr_b16 v[162:163], v71 offset:12864
  ds_read_b64_tr_b16 v[164:165], v71 offset:12384
  ds_read_b64_tr_b16 v[166:167], v71 offset:12896
  s_waitcnt lgkmcnt(0)
  v_mfma_f32_16x16x32_bf16 v[168:171], v[20:23], v[152:155], v[168:171]
  v_mfma_f32_16x16x32_bf16 v[172:175], v[20:23], v[156:159], v[172:175]
  v_mfma_f32_16x16x32_bf16 v[176:179], v[20:23], v[160:163], v[176:179]
  v_mfma_f32_16x16x32_bf16 v[180:183], v[20:23], v[164:167], v[180:183]
  ds_read_b64_tr_b16 v[136:137], v71 offset:16384
  ds_read_b64_tr_b16 v[138:139], v71 offset:16896
  ds_read_b64_tr_b16 v[140:141], v71 offset:16416
  ds_read_b64_tr_b16 v[142:143], v71 offset:16928
  ds_read_b64_tr_b16 v[144:145], v71 offset:16448
  ds_read_b64_tr_b16 v[146:147], v71 offset:16960
  ds_read_b64_tr_b16 v[148:149], v71 offset:16480
  ds_read_b64_tr_b16 v[150:151], v71 offset:16992
  s_waitcnt lgkmcnt(0)
  v_mfma_f32_16x16x32_bf16 v[168:171], v[24:27], v[136:139], v[168:171]
  v_mfma_f32_16x16x32_bf16 v[172:175], v[24:27], v[140:143], v[172:175]
  v_mfma_f32_16x16x32_bf16 v[176:179], v[24:27], v[144:147], v[176:179]
  v_mfma_f32_16x16x32_bf16 v[180:183], v[24:27], v[148:151], v[180:183]
  ds_read_b64_tr_b16 v[152:153], v71 offset:20480
  ds_read_b64_tr_b16 v[154:155], v71 offset:20992
  ds_read_b64_tr_b16 v[156:157], v71 offset:20512
  ds_read_b64_tr_b16 v[158:159], v71 offset:21024
  ds_read_b64_tr_b16 v[160:161], v71 offset:20544
  ds_read_b64_tr_b16 v[162:163], v71 offset:21056
  ds_read_b64_tr_b16 v[164:165], v71 offset:20576
  ds_read_b64_tr_b16 v[166:167], v71 offset:21088
  s_waitcnt lgkmcnt(0)
  v_mfma_f32_16x16x32_bf16 v[168:171], v[28:31], v[152:155], v[168:171]
  v_mfma_f32_16x16x32_bf16 v[172:175], v[28:31], v[156:159], v[172:175]
  v_mfma_f32_16x16x32_bf16 v[176:179], v[28:31], v[160:163], v[176:179]
  v_mfma_f32_16x16x32_bf16 v[180:183], v[28:31], v[164:167], v[180:183]
  ds_read_b64_tr_b16 v[136:137], v71 offset:24576
  ds_read_b64_tr_b16 v[138:139], v71 offset:25088
  ds_read_b64_tr_b16 v[140:141], v71 offset:24608
  ds_read_b64_tr_b16 v[142:143], v71 offset:25120
  ds_read_b64_tr_b16 v[144:145], v71 offset:24640
  ds_read_b64_tr_b16 v[146:147], v71 offset:25152
  ds_read_b64_tr_b16 v[148:149], v71 offset:24672
  ds_read_b64_tr_b16 v[150:151], v71 offset:25184
  s_waitcnt lgkmcnt(0)
  v_mfma_f32_16x16x32_bf16 v[168:171], v[32:35], v[136:139], v[168:171]
  v_mfma_f32_16x16x32_bf16 v[172:175], v[32:35], v[140:143], v[172:175]
  v_mfma_f32_16x16x32_bf16 v[176:179], v[32:35], v[144:147], v[176:179]
  v_mfma_f32_16x16x32_bf16 v[180:183], v[32:35], v[148:151], v[180:183]
  ds_read_b64_tr_b16 v[152:153], v71 offset:28672
  ds_read_b64_tr_b16 v[154:155], v71 offset:29184
  ds_read_b64_tr_b16 v[156:157], v71 offset:28704
  ds_read_b64_tr_b16 v[158:159], v71 offset:29216
  ds_read_b64_tr_b16 v[160:161], v71 offset:28736
  ds_read_b64_tr_b16 v[162:163], v71 offset:29248
  ds_read_b64_tr_b16 v[164:165], v71 offset:28768
  ds_read_b64_tr_b16 v[166:167], v71 offset:29280
  s_waitcnt lgkmcnt(0)
  v_mfma_f32_16x16x32_bf16 v[168:171], v[36:39], v[152:155], v[168:171]
  v_mfma_f32_16x16x32_bf16 v[172:175], v[36:39], v[156:159], v[172:175]
  v_mfma_f32_16x16x32_bf16 v[176:179], v[36:39], v[160:163], v[176:179]
  v_mfma_f32_16x16x32_bf16 v[180:183], v[36:39], v[164:167], v[180:183]
  ds_read_b64_tr_b16 v[136:137], v71 offset:32768
  ds_read_b64_tr_b16 v[138:139], v71 offset:33280
  ds_read_b64_tr_b16 v[140:141], v71 offset:32800
  ds_read_b64_tr_b16 v[142:143], v71 offset:33312
  ds_read_b64_tr_b16 v[144:145], v71 offset:32832
  ds_read_b64_tr_b16 v[146:147], v71 offset:33344
  ds_read_b64_tr_b16 v[148:149], v71 offset:32864
  ds_read_b64_tr_b16 v[150:151], v71 offset:33376
  s_waitcnt lgkmcnt(0)
  v_mfma_f32_16x16x32_bf16 v[168:171], v[40:43], v[136:139], v[168:171]
  v_mfma_f32_16x16x32_bf16 v[172:175], v[40:43], v[140:143], v[172:175]
  v_mfma_f32_16x16x32_bf16 v[176:179], v[40:43], v[144:147], v[176:179]
  v_mfma_f32_16x16x32_bf16 v[180:183], v[40:43], v[148:151], v[180:183]
  ds_read_b64_tr_b16 v[152:153], v71 offset:36864
  ds_read_b64_tr_b16 v[154:155], v71 offset:37376
  ds_read_b64_tr_b16 v[156:157], v71 offset:36896
  ds_read_b64_tr_b16 v[158:159], v71 offset:37408
  ds_read_b64_tr_b16 v[160:161], v71 offset:36928
  ds_read_b64_tr_b16 v[162:163], v71 offset:37440
  ds_read_b64_tr_b16 v[164:165], v71 offset:36960
  ds_read_b64_tr_b16 v[166:167], v71 offset:37472
  s_waitcnt lgkmcnt(0)
  v_mfma_f32_16x16x32_bf16 v[168:171], v[44:47], v[152:155], v[168:171]
  v_mfma_f32_16x16x32_bf16 v[172:175], v[44:47], v[156:159], v[172:175]
  v_mfma_f32_16x16x32_bf16 v[176:179], v[44:47], v[160:163], v[176:179]
  v_mfma_f32_16x16x32_bf16 v[180:183], v[44:47], v[164:167], v[180:183]
  ds_read_b64_tr_b16 v[136:137], v71 offset:40960
  ds_read_b64_tr_b16 v[138:139], v71 offset:41472
  ds_read_b64_tr_b16 v[140:141], v71 offset:40992
  ds_read_b64_tr_b16 v[142:143], v71 offset:41504
  ds_read_b64_tr_b16 v[144:145], v71 offset:41024
  ds_read_b64_tr_b16 v[146:147], v71 offset:41536
  ds_read_b64_tr_b16 v[148:149], v71 offset:41056
  ds_read_b64_tr_b16 v[150:151], v71 offset:41568
  s_waitcnt lgkmcnt(0)
  v_mfma_f32_16x16x32_bf16 v[168:171], v[48:51], v[136:139], v[168:171]
  v_mfma_f32_16x16x32_bf16 v[172:175], v[48:51], v[140:143], v[172:175]
  v_mfma_f32_16x16x32_bf16 v[176:179], v[48:51], v[144:147], v[176:179]
  v_mfma_f32_16x16x32_bf16 v[180:183], v[48:51], v[148:151], v[180:183]
  ds_read_b64_tr_b16 v[152:153], v71 offset:45056
  ds_read_b64_tr_b16 v[154:155], v71 offset:45568
  ds_read_b64_tr_b16 v[156:157], v71 offset:45088
  ds_read_b64_tr_b16 v[158:159], v71 offset:45600
  ds_read_b64_tr_b16 v[160:161], v71 offset:45120
  ds_read_b64_tr_b16 v[162:163], v71 offset:45632
  ds_read_b64_tr_b16 v[164:165], v71 offset:45152
  ds_read_b64_tr_b16 v[166:167], v71 offset:45664
  s_waitcnt lgkmcnt(0)
  v_mfma_f32_16x16x32_bf16 v[168:171], v[52:55], v[152:155], v[168:171]
  v_mfma_f32_16x16x32_bf16 v[172:175], v[52:55], v[156:159], v[172:175]
  v_mfma_f32_16x16x32_bf16 v[176:179], v[52:55], v[160:163], v[176:179]
  v_mfma_f32_16x16x32_bf16 v[180:183], v[52:55], v[164:167], v[180:183]
  ds_read_b64_tr_b16 v[136:137], v71 offset:49152
  ds_read_b64_tr_b16 v[138:139], v71 offset:49664
  ds_read_b64_tr_b16 v[140:141], v71 offset:49184
  ds_read_b64_tr_b16 v[142:143], v71 offset:49696
  ds_read_b64_tr_b16 v[144:145], v71 offset:49216
  ds_read_b64_tr_b16 v[146:147], v71 offset:49728
  ds_read_b64_tr_b16 v[148:149], v71 offset:49248
  ds_read_b64_tr_b16 v[150:151], v71 offset:49760
  s_waitcnt lgkmcnt(0)
  v_mfma_f32_16x16x32_bf16 v[168:171], v[56:59], v[136:139], v[168:171]
  v_mfma_f32_16x16x32_bf16 v[172:175], v[56:59], v[140:143], v[172:175]
  v_mfma_f32_16x16x32_bf16 v[176:179], v[56:59], v[144:147], v[176:179]
  v_mfma_f32_16x16x32_bf16 v[180:183], v[56:59], v[148:151], v[180:183]
  ds_read_b64_tr_b16 v[152:153], v71 offset:53248
  ds_read_b64_tr_b16 v[154:155], v71 offset:53760
  ds_read_b64_tr_b16 v[156:157], v71 offset:53280
  ds_read_b64_tr_b16 v[158:159], v71 offset:53792
  ds_read_b64_tr_b16 v[160:161], v71 offset:53312
  ds_read_b64_tr_b16 v[162:163], v71 offset:53824
  ds_read_b64_tr_b16 v[164:165], v71 offset:53344
  ds_read_b64_tr_b16 v[166:167], v71 offset:53856
  s_waitcnt lgkmcnt(0)
  v_mfma_f32_16x16x32_bf16 v[168:171], v[60:63], v[152:155], v[168:171]
  v_mfma_f32_16x16x32_bf16 v[172:175], v[60:63], v[156:159], v[172:175]
  v_mfma_f32_16x16x32_bf16 v[176:179], v[60:63], v[160:163], v[176:179]
  v_mfma_f32_16x16x32_bf16 v[180:183], v[60:63], v[164:167], v[180:183]
  s_nop 7
  v_cndmask_b32 v104, v112, v114, s[54:55]
  v_cndmask_b32 v105, v113, v115, s[54:55]
  s_nop 1
  v_mov_b32_dpp v106, v104 quad_perm:[1,0,3,2] row_mask:0xf bank_mask:0xf
  v_mov_b32_dpp v107, v105 quad_perm:[1,0,3,2] row_mask:0xf bank_mask:0xf
  v_cndmask_b32 v77, v106, v105, s[56:57]
  v_cndmask_b32 v76, v104, v107, s[56:57]
  v_cndmask_b32 v104, v168, v170, s[54:55]
  v_cndmask_b32 v105, v169, v171, s[54:55]
  s_nop 1
  v_mov_b32_dpp v106, v104 quad_perm:[1,0,3,2] row_mask:0xf bank_mask:0xf
  v_mov_b32_dpp v107, v105 quad_perm:[1,0,3,2] row_mask:0xf bank_mask:0xf
  v_cndmask_b32 v79, v106, v105, s[56:57]
  v_cndmask_b32 v78, v104, v107, s[56:57]
  v_cvt_pk_bf16_f32 v77, v76, v77
  v_lshlrev_b32 v76, 16, v77
  v_and_b32 v77, 0xffff0000, v77
  v_cvt_pk_bf16_f32 v79, v78, v79
  v_lshlrev_b32 v78, 16, v79
  v_and_b32 v79, 0xffff0000, v79
  v_mul_f32 v76, v76, v78
  v_mul_f32 v77, v77, v79
  v_cvt_pk_bf16_f32 v72, v76, v77
  v_cndmask_b32 v104, v116, v118, s[54:55]
  v_cndmask_b32 v105, v117, v119, s[54:55]
  s_nop 1
  v_mov_b32_dpp v106, v104 quad_perm:[1,0,3,2] row_mask:0xf bank_mask:0xf
  v_mov_b32_dpp v107, v105 quad_perm:[1,0,3,2] row_mask:0xf bank_mask:0xf
  v_cndmask_b32 v77, v106, v105, s[56:57]
  v_cndmask_b32 v76, v104, v107, s[56:57]
  v_cndmask_b32 v104, v172, v174, s[54:55]
  v_cndmask_b32 v105, v173, v175, s[54:55]
  s_nop 1
  v_mov_b32_dpp v106, v104 quad_perm:[1,0,3,2] row_mask:0xf bank_mask:0xf
  v_mov_b32_dpp v107, v105 quad_perm:[1,0,3,2] row_mask:0xf bank_mask:0xf
  v_cndmask_b32 v79, v106, v105, s[56:57]
  v_cndmask_b32 v78, v104, v107, s[56:57]
  v_cvt_pk_bf16_f32 v77, v76, v77
  v_lshlrev_b32 v76, 16, v77
  v_and_b32 v77, 0xffff0000, v77
  v_cvt_pk_bf16_f32 v79, v78, v79
  v_lshlrev_b32 v78, 16, v79
  v_and_b32 v79, 0xffff0000, v79
  v_mul_f32 v76, v76, v78
  v_mul_f32 v77, v77, v79
  v_cvt_pk_bf16_f32 v73, v76, v77
  v_cndmask_b32 v104, v120, v122, s[54:55]
  v_cndmask_b32 v105, v121, v123, s[54:55]
  s_nop 1
  v_mov_b32_dpp v106, v104 quad_perm:[1,0,3,2] row_mask:0xf bank_mask:0xf
  v_mov_b32_dpp v107, v105 quad_perm:[1,0,3,2] row_mask:0xf bank_mask:0xf
  v_cndmask_b32 v77, v106, v105, s[56:57]
  v_cndmask_b32 v76, v104, v107, s[56:57]
  v_cndmask_b32 v104, v176, v178, s[54:55]
  v_cndmask_b32 v105, v177, v179, s[54:55]
  s_nop 1
  v_mov_b32_dpp v106, v104 quad_perm:[1,0,3,2] row_mask:0xf bank_mask:0xf
  v_mov_b32_dpp v107, v105 quad_perm:[1,0,3,2] row_mask:0xf bank_mask:0xf
  v_cndmask_b32 v79, v106, v105, s[56:57]
  v_cndmask_b32 v78, v104, v107, s[56:57]
  v_cvt_pk_bf16_f32 v77, v76, v77
  v_lshlrev_b32 v76, 16, v77
  v_and_b32 v77, 0xffff0000, v77
  v_cvt_pk_bf16_f32 v79, v78, v79
  v_lshlrev_b32 v78, 16, v79
  v_and_b32 v79, 0xffff0000, v79
  v_mul_f32 v76, v76, v78
  v_mul_f32 v77, v77, v79
  v_cvt_pk_bf16_f32 v74, v76, v77
  v_cndmask_b32 v104, v124, v126, s[54:55]
  v_cndmask_b32 v105, v125, v127, s[54:55]
  s_nop 1
  v_mov_b32_dpp v106, v104 quad_perm:[1,0,3,2] row_mask:0xf bank_mask:0xf
  v_mov_b32_dpp v107, v105 quad_perm:[1,0,3,2] row_mask:0xf bank_mask:0xf
  v_cndmask_b32 v77, v106, v105, s[56:57]
  v_cndmask_b32 v76, v104, v107, s[56:57]
  v_cndmask_b32 v104, v180, v182, s[54:55]
  v_cndmask_b32 v105, v181, v183, s[54:55]
  s_nop 1
  v_mov_b32_dpp v106, v104 quad_perm:[1,0,3,2] row_mask:0xf bank_mask:0xf
  v_mov_b32_dpp v107, v105 quad_perm:[1,0,3,2] row_mask:0xf bank_mask:0xf
  v_cndmask_b32 v79, v106, v105, s[56:57]
  v_cndmask_b32 v78, v104, v107, s[56:57]
  v_cvt_pk_bf16_f32 v77, v76, v77
  v_lshlrev_b32 v76, 16, v77
  v_and_b32 v77, 0xffff0000, v77
  v_cvt_pk_bf16_f32 v79, v78, v79
  v_lshlrev_b32 v78, 16, v79
  v_and_b32 v79, 0xffff0000, v79
  v_mul_f32 v76, v76, v78
  v_mul_f32 v77, v77, v79
  v_cvt_pk_bf16_f32 v75, v76, v77
  v_mul_u32_u24 v69, 3584, v67
  v_lshl_add_u32 v69, v68, 1, v69
  s_lshl_b32 s38, s58, 7
  s_add_u32 s38, s38, 135168
  buffer_store_dwordx4 v[72:75], v69, s[12:15], s38 offen sc1
  s_branch L_flag
L_j3:
  s_sub_u32 s38, s58, 28
  s_cmp_ge_u32 s38, 7
  s_cselect_b32 s39, 1, 0
  s_mul_i32 s40, s39, 7
  s_sub_u32 s40, s38, s40
  s_lshl_b32 s40, s40, 7
  s_mul_i32 s42, s39, 802816
  s_add_u32 s42, s42, s40
  v_lshrrev_b32 v2, 4, v1
  v_bfe_u32 v7, v1, 3, 1
  v_lshl_add_u32 v2, v2, 4, v7
  v_mul_u32_u24 v2, 896, v2
  v_and_b32 v7, 7, v1
  v_lshl_add_u32 v2, v7, 4, v2
  v_mul_u32_u24 v69, 3584, v7
  v_lshl_add_u32 v69, v5, 4, v69
  v_bfe_u32 v71, v1, 3, 1
  v_mul_u32_u24 v71, 896, v71
  v_add_u32 v69, v69, v71
  v_add_u32 v71, 35840, v65
  s_mul_i32 s43, s39, 1792
  s_add_u32 s52, s43, 163840
  s_add_u32 s43, s43, 135168
  s_mov_b32 s4, s64
  s_mov_b32 s5, s65
  s_mov_b32 s6, 1605632
  s_mov_b32 s7, 0x20000
  s_lshl_b32 s40, s3, 11
  s_add_u32 m0, s40, 35840
  s_mul_i32 s40, s3, 3584
  s_add_u32 s40, s40, s42
  s_mov_b32 s41, 14
L_dma_19:
  buffer_load_dwordx4 v2, s[4:7], s40 offen nt lds
  s_add_u32 m0, m0, 1024
  s_add_u32 s40, s40, 1792
  buffer_load_dwordx4 v2, s[4:7], s40 offen nt lds
  s_add_u32 m0, m0, 7168
  s_add_u32 s40, s40, 55552
  s_sub_u32 s41, s41, 1
  s_cmp_lg_u32 s41, 0
  s_cbranch_scc1 L_dma_19
  s_waitcnt vmcnt(0) lgkmcnt(0)
  v_mov_b32 v6, 0
  v_mov_b32 v7, 1
  s_mov_b64 exec, 1
  ds_add_u32 v6, v7 offset:18956
  s_mov_b64 exec, -1
  s_cmp_lg_u32 s3, 0
  s_cbranch_scc1 L_wo
  v_mov_b32 v6, 0
L_lw_20:
  s_sleep 4
  ds_read_b32 v7, v6 offset:18956
  s_waitcnt lgkmcnt(0)
  v_readfirstlane_b32 s40, v7
  s_cmp_lt_u32 s40, 4
  s_cbranch_scc1 L_lw_20
  v_min_u32 v6, 13, v1
  v_lshlrev_b32 v6, 7, v6
  s_mov_b32 s41, 20000
L_hf_21:
  buffer_load_dword v72, v6, s[12:15], s52 offen sc1
  s_waitcnt vmcnt(0)
  v_xor_b32 v104, s33, v72
  v_cmp_ne_u32 vcc, 0, v104
  s_nop 4
  s_cbranch_vccz L_dn_22
  s_sub_u32 s41, s41, 1
  s_cmp_eq_u32 s41, 0
  s_cbranch_scc1 L_dn_22
  s_sleep 64
  s_branch L_hf_21
L_dn_22:
  buffer_load_dwordx4 v[8:11], v69, s[12:15], s43 offen offset:0 sc1
  buffer_load_dwordx4 v[12:15], v69, s[12:15], s43 offen offset:64 sc1
  buffer_load_dwordx4 v[16:19], v69, s[12:15], s43 offen offset:128 sc1
  buffer_load_dwordx4 v[20:23], v69, s[12:15], s43 offen offset:192 sc1
  buffer_load_dwordx4 v[24:27], v69, s[12:15], s43 offen offset:256 sc1
  buffer_load_dwordx4 v[28:31], v69, s[12:15], s43 offen offset:320 sc1
  buffer_load_dwordx4 v[32:35], v69, s[12:15], s43 offen offset:384 sc1
  buffer_load_dwordx4 v[36:39], v69, s[12:15], s43 offen offset:448 sc1
  buffer_load_dwordx4 v[40:43], v69, s[12:15], s43 offen offset:512 sc1
  buffer_load_dwordx4 v[44:47], v69, s[12:15], s43 offen offset:576 sc1
  buffer_load_dwordx4 v[48:51], v69, s[12:15], s43 offen offset:640 sc1
  buffer_load_dwordx4 v[52:55], v69, s[12:15], s43 offen offset:704 sc1
  buffer_load_dwordx4 v[56:59], v69, s[12:15], s43 offen offset:768 sc1
  buffer_load_dwordx4 v[60:63], v69, s[12:15], s43 offen offset:832 sc1
  s_waitcnt vmcnt(0)
  ds_read_b64_tr_b16 v[136:137], v71 offset:0
  ds_read_b64_tr_b16 v[138:139], v71 offset:512
  ds_read_b64_tr_b16 v[140:141], v71 offset:32
  ds_read_b64_tr_b16 v[142:143], v71 offset:544
  ds_read_b64_tr_b16 v[144:145], v71 offset:64
  ds_read_b64_tr_b16 v[146:147], v71 offset:576
  ds_read_b64_tr_b16 v[148:149], v71 offset:96
  ds_read_b64_tr_b16 v[150:151], v71 offset:608
  s_waitcnt lgkmcnt(0)
  v_mfma_f32_16x16x32_bf16 v[112:115], v[8:11], v[136:139], 0
  v_mfma_f32_16x16x32_bf16 v[116:119], v[8:11], v[140:143], 0
  v_mfma_f32_16x16x32_bf16 v[120:123], v[8:11], v[144:147], 0
  v_mfma_f32_16x16x32_bf16 v[124:127], v[8:11], v[148:151], 0
  ds_read_b64_tr_b16 v[152:153], v71 offset:4096
  ds_read_b64_tr_b16 v[154:155], v71 offset:4608
  ds_read_b64_tr_b16 v[156:157], v71 offset:4128
  ds_read_b64_tr_b16 v[158:159], v71 offset:4640
  ds_read_b64_tr_b16 v[160:161], v71 offset:4160
  ds_read_b64_tr_b16 v[162:163], v71 offset:4672
  ds_read_b64_tr_b16 v[164:165], v71 offset:4192
  ds_read_b64_tr_b16 v[166:167], v71 offset:4704
  s_waitcnt lgkmcnt(0)
  v_mfma_f32_16x16x32_bf16 v[112:115], v[12:15], v[152:155], v[112:115]
  v_mfma_f32_16x16x32_bf16 v[116:119], v[12:15], v[156:159], v[116:119]
  v_mfma_f32_16x16x32_bf16 v[120:123], v[12:15], v[160:163], v[120:123]
  v_mfma_f32_16x16x32_bf16 v[124:127], v[12:15], v[164:167], v[124:127]
  ds_read_b64_tr_b16 v[136:137], v71 offset:8192
  ds_read_b64_tr_b16 v[138:139], v71 offset:8704
  ds_read_b64_tr_b16 v[140:141], v71 offset:8224
  ds_read_b64_tr_b16 v[142:143], v71 offset:8736
  ds_read_b64_tr_b16 v[144:145], v71 offset:8256
  ds_read_b64_tr_b16 v[146:147], v71 offset:8768
  ds_read_b64_tr_b16 v[148:149], v71 offset:8288
  ds_read_b64_tr_b16 v[150:151], v71 offset:8800
  s_waitcnt lgkmcnt(0)
  v_mfma_f32_16x16x32_bf16 v[112:115], v[16:19], v[136:139], v[112:115]
  v_mfma_f32_16x16x32_bf16 v[116:119], v[16:19], v[140:143], v[116:119]
  v_mfma_f32_16x16x32_bf16 v[120:123], v[16:19], v[144:147], v[120:123]
  v_mfma_f32_16x16x32_bf16 v[124:127], v[16:19], v[148:151], v[124:127]
  ds_read_b64_tr_b16 v[152:153], v71 offset:12288
  ds_read_b64_tr_b16 v[154:155], v71 offset:12800
  ds_read_b64_tr_b16 v[156:157], v71 offset:12320
  ds_read_b64_tr_b16 v[158:159], v71 offset:12832
  ds_read_b64_tr_b16 v[160:161], v71 offset:12352
  ds_read_b64_tr_b16 v[162:163], v71 offset:12864
  ds_read_b64_tr_b16 v[164:165], v71 offset:12384
  ds_read_b64_tr_b16 v[166:167], v71 offset:12896
  s_waitcnt lgkmcnt(0)
  v_mfma_f32_16x16x32_bf16 v[112:115], v[20:23], v[152:155], v[112:115]
  v_mfma_f32_16x16x32_bf16 v[116:119], v[20:23], v[156:159], v[116:119]
  v_mfma_f32_16x16x32_bf16 v[120:123], v[20:23], v[160:163], v[120:123]
  v_mfma_f32_16x16x32_bf16 v[124:127], v[20:23], v[164:167], v[124:127]
  ds_read_b64_tr_b16 v[136:137], v71 offset:16384
  ds_read_b64_tr_b16 v[138:139], v71 offset:16896
  ds_read_b64_tr_b16 v[140:141], v71 offset:16416
  ds_read_b64_tr_b16 v[142:143], v71 offset:16928
  ds_read_b64_tr_b16 v[144:145], v71 offset:16448
  ds_read_b64_tr_b16 v[146:147], v71 offset:16960
  ds_read_b64_tr_b16 v[148:149], v71 offset:16480
  ds_read_b64_tr_b16 v[150:151], v71 offset:16992
  s_waitcnt lgkmcnt(0)
  v_mfma_f32_16x16x32_bf16 v[112:115], v[24:27], v[136:139], v[112:115]
  v_mfma_f32_16x16x32_bf16 v[116:119], v[24:27], v[140:143], v[116:119]
  v_mfma_f32_16x16x32_bf16 v[120:123], v[24:27], v[144:147], v[120:123]
  v_mfma_f32_16x16x32_bf16 v[124:127], v[24:27], v[148:151], v[124:127]
  ds_read_b64_tr_b16 v[152:153], v71 offset:20480
  ds_read_b64_tr_b16 v[154:155], v71 offset:20992
  ds_read_b64_tr_b16 v[156:157], v71 offset:20512
  ds_read_b64_tr_b16 v[158:159], v71 offset:21024
  ds_read_b64_tr_b16 v[160:161], v71 offset:20544
  ds_read_b64_tr_b16 v[162:163], v71 offset:21056
  ds_read_b64_tr_b16 v[164:165], v71 offset:20576
  ds_read_b64_tr_b16 v[166:167], v71 offset:21088
  s_waitcnt lgkmcnt(0)
  v_mfma_f32_16x16x32_bf16 v[112:115], v[28:31], v[152:155], v[112:115]
  v_mfma_f32_16x16x32_bf16 v[116:119], v[28:31], v[156:159], v[116:119]
  v_mfma_f32_16x16x32_bf16 v[120:123], v[28:31], v[160:163], v[120:123]
  v_mfma_f32_16x16x32_bf16 v[124:127], v[28:31], v[164:167], v[124:127]
  ds_read_b64_tr_b16 v[136:137], v71 offset:24576
  ds_read_b64_tr_b16 v[138:139], v71 offset:25088
  ds_read_b64_tr_b16 v[140:141], v71 offset:24608
  ds_read_b64_tr_b16 v[142:143], v71 offset:25120
  ds_read_b64_tr_b16 v[144:145], v71 offset:24640
  ds_read_b64_tr_b16 v[146:147], v71 offset:25152
  ds_read_b64_tr_b16 v[148:149], v71 offset:24672
  ds_read_b64_tr_b16 v[150:151], v71 offset:25184
  s_waitcnt lgkmcnt(0)
  v_mfma_f32_16x16x32_bf16 v[112:115], v[32:35], v[136:139], v[112:115]
  v_mfma_f32_16x16x32_bf16 v[116:119], v[32:35], v[140:143], v[116:119]
  v_mfma_f32_16x16x32_bf16 v[120:123], v[32:35], v[144:147], v[120:123]
  v_mfma_f32_16x16x32_bf16 v[124:127], v[32:35], v[148:151], v[124:127]
  ds_read_b64_tr_b16 v[152:153], v71 offset:28672
  ds_read_b64_tr_b16 v[154:155], v71 offset:29184
  ds_read_b64_tr_b16 v[156:157], v71 offset:28704
  ds_read_b64_tr_b16 v[158:159], v71 offset:29216
  ds_read_b64_tr_b16 v[160:161], v71 offset:28736
  ds_read_b64_tr_b16 v[162:163], v71 offset:29248
  ds_read_b64_tr_b16 v[164:165], v71 offset:28768
  ds_read_b64_tr_b16 v[166:167], v71 offset:29280
  s_waitcnt lgkmcnt(0)
  v_mfma_f32_16x16x32_bf16 v[112:115], v[36:39], v[152:155], v[112:115]
  v_mfma_f32_16x16x32_bf16 v[116:119], v[36:39], v[156:159], v[116:119]
  v_mfma_f32_16x16x32_bf16 v[120:123], v[36:39], v[160:163], v[120:123]
  v_mfma_f32_16x16x32_bf16 v[124:127], v[36:39], v[164:167], v[124:127]
  ds_read_b64_tr_b16 v[136:137], v71 offset:32768
  ds_read_b64_tr_b16 v[138:139], v71 offset:33280
  ds_read_b64_tr_b16 v[140:141], v71 offset:32800
  ds_read_b64_tr_b16 v[142:143], v71 offset:33312
  ds_read_b64_tr_b16 v[144:145], v71 offset:32832
  ds_read_b64_tr_b16 v[146:147], v71 offset:33344
  ds_read_b64_tr_b16 v[148:149], v71 offset:32864
  ds_read_b64_tr_b16 v[150:151], v71 offset:33376
  s_waitcnt lgkmcnt(0)
  v_mfma_f32_16x16x32_bf16 v[112:115], v[40:43], v[136:139], v[112:115]
  v_mfma_f32_16x16x32_bf16 v[116:119], v[40:43], v[140:143], v[116:119]
  v_mfma_f32_16x16x32_bf16 v[120:123], v[40:43], v[144:147], v[120:123]
  v_mfma_f32_16x16x32_bf16 v[124:127], v[40:43], v[148:151], v[124:127]
  ds_read_b64_tr_b16 v[152:153], v71 offset:36864
  ds_read_b64_tr_b16 v[154:155], v71 offset:37376
  ds_read_b64_tr_b16 v[156:157], v71 offset:36896
  ds_read_b64_tr_b16 v[158:159], v71 offset:37408
  ds_read_b64_tr_b16 v[160:161], v71 offset:36928
  ds_read_b64_tr_b16 v[162:163], v71 offset:37440
  ds_read_b64_tr_b16 v[164:165], v71 offset:36960
  ds_read_b64_tr_b16 v[166:167], v71 offset:37472
  s_waitcnt lgkmcnt(0)
  v_mfma_f32_16x16x32_bf16 v[112:115], v[44:47], v[152:155], v[112:115]
  v_mfma_f32_16x16x32_bf16 v[116:119], v[44:47], v[156:159], v[116:119]
  v_mfma_f32_16x16x32_bf16 v[120:123], v[44:47], v[160:163], v[120:123]
  v_mfma_f32_16x16x32_bf16 v[124:127], v[44:47], v[164:167], v[124:127]
  ds_read_b64_tr_b16 v[136:137], v71 offset:40960
  ds_read_b64_tr_b16 v[138:139], v71 offset:41472
  ds_read_b64_tr_b16 v[140:141], v71 offset:40992
  ds_read_b64_tr_b16 v[142:143], v71 offset:41504
  ds_read_b64_tr_b16 v[144:145], v71 offset:41024
  ds_read_b64_tr_b16 v[146:147], v71 offset:41536
  ds_read_b64_tr_b16 v[148:149], v71 offset:41056
  ds_read_b64_tr_b16 v[150:151], v71 offset:41568
  s_waitcnt lgkmcnt(0)
  v_mfma_f32_16x16x32_bf16 v[112:115], v[48:51], v[136:139], v[112:115]
  v_mfma_f32_16x16x32_bf16 v[116:119], v[48:51], v[140:143], v[116:119]
  v_mfma_f32_16x16x32_bf16 v[120:123], v[48:51], v[144:147], v[120:123]
  v_mfma_f32_16x16x32_bf16 v[124:127], v[48:51], v[148:151], v[124:127]
  ds_read_b64_tr_b16 v[152:153], v71 offset:45056
  ds_read_b64_tr_b16 v[154:155], v71 offset:45568
  ds_read_b64_tr_b16 v[156:157], v71 offset:45088
  ds_read_b64_tr_b16 v[158:159], v71 offset:45600
  ds_read_b64_tr_b16 v[160:161], v71 offset:45120
  ds_read_b64_tr_b16 v[162:163], v71 offset:45632
  ds_read_b64_tr_b16 v[164:165], v71 offset:45152
  ds_read_b64_tr_b16 v[166:167], v71 offset:45664
  s_waitcnt lgkmcnt(0)
  v_mfma_f32_16x16x32_bf16 v[112:115], v[52:55], v[152:155], v[112:115]
  v_mfma_f32_16x16x32_bf16 v[116:119], v[52:55], v[156:159], v[116:119]
  v_mfma_f32_16x16x32_bf16 v[120:123], v[52:55], v[160:163], v[120:123]
  v_mfma_f32_16x16x32_bf16 v[124:127], v[52:55], v[164:167], v[124:127]
  ds_read_b64_tr_b16 v[136:137], v71 offset:49152
  ds_read_b64_tr_b16 v[138:139], v71 offset:49664
  ds_read_b64_tr_b16 v[140:141], v71 offset:49184
  ds_read_b64_tr_b16 v[142:143], v71 offset:49696
  ds_read_b64_tr_b16 v[144:145], v71 offset:49216
  ds_read_b64_tr_b16 v[146:147], v71 offset:49728
  ds_read_b64_tr_b16 v[148:149], v71 offset:49248
  ds_read_b64_tr_b16 v[150:151], v71 offset:49760
  s_waitcnt lgkmcnt(0)
  v_mfma_f32_16x16x32_bf16 v[112:115], v[56:59], v[136:139], v[112:115]
  v_mfma_f32_16x16x32_bf16 v[116:119], v[56:59], v[140:143], v[116:119]
  v_mfma_f32_16x16x32_bf16 v[120:123], v[56:59], v[144:147], v[120:123]
  v_mfma_f32_16x16x32_bf16 v[124:127], v[56:59], v[148:151], v[124:127]
  ds_read_b64_tr_b16 v[152:153], v71 offset:53248
  ds_read_b64_tr_b16 v[154:155], v71 offset:53760
  ds_read_b64_tr_b16 v[156:157], v71 offset:53280
  ds_read_b64_tr_b16 v[158:159], v71 offset:53792
  ds_read_b64_tr_b16 v[160:161], v71 offset:53312
  ds_read_b64_tr_b16 v[162:163], v71 offset:53824
  ds_read_b64_tr_b16 v[164:165], v71 offset:53344
  ds_read_b64_tr_b16 v[166:167], v71 offset:53856
  s_waitcnt lgkmcnt(0)
  v_mfma_f32_16x16x32_bf16 v[112:115], v[60:63], v[152:155], v[112:115]
  v_mfma_f32_16x16x32_bf16 v[116:119], v[60:63], v[156:159], v[116:119]
  v_mfma_f32_16x16x32_bf16 v[120:123], v[60:63], v[160:163], v[120:123]
  v_mfma_f32_16x16x32_bf16 v[124:127], v[60:63], v[164:167], v[124:127]
  v_add_u32 v71, 93184, v65
  s_waitcnt vmcnt(0)
  ds_read_b64_tr_b16 v[136:137], v71 offset:0
  ds_read_b64_tr_b16 v[138:139], v71 offset:512
  ds_read_b64_tr_b16 v[140:141], v71 offset:32
  ds_read_b64_tr_b16 v[142:143], v71 offset:544
  ds_read_b64_tr_b16 v[144:145], v71 offset:64
  ds_read_b64_tr_b16 v[146:147], v71 offset:576
  ds_read_b64_tr_b16 v[148:149], v71 offset:96
  ds_read_b64_tr_b16 v[150:151], v71 offset:608
  s_waitcnt lgkmcnt(0)
  v_mfma_f32_16x16x32_bf16 v[168:171], v[8:11], v[136:139], 0
  v_mfma_f32_16x16x32_bf16 v[172:175], v[8:11], v[140:143], 0
  v_mfma_f32_16x16x32_bf16 v[176:179], v[8:11], v[144:147], 0
  v_mfma_f32_16x16x32_bf16 v[180:183], v[8:11], v[148:151], 0
  ds_read_b64_tr_b16 v[152:153], v71 offset:4096
  ds_read_b64_tr_b16 v[154:155], v71 offset:4608
  ds_read_b64_tr_b16 v[156:157], v71 offset:4128
  ds_read_b64_tr_b16 v[158:159], v71 offset:4640
  ds_read_b64_tr_b16 v[160:161], v71 offset:4160
  ds_read_b64_tr_b16 v[162:163], v71 offset:4672
  ds_read_b64_tr_b16 v[164:165], v71 offset:4192
  ds_read_b64_tr_b16 v[166:167], v71 offset:4704
  s_waitcnt lgkmcnt(0)
  v_mfma_f32_16x16x32_bf16 v[168:171], v[12:15], v[152:155], v[168:171]
  v_mfma_f32_16x16x32_bf16 v[172:175], v[12:15], v[156:159], v[172:175]
  v_mfma_f32_16x16x32_bf16 v[176:179], v[12:15], v[160:163], v[176:179]
  v_mfma_f32_16x16x32_bf16 v[180:183], v[12:15], v[164:167], v[180:183]
  ds_read_b64_tr_b16 v[136:137], v71 offset:8192
  ds_read_b64_tr_b16 v[138:139], v71 offset:8704
  ds_read_b64_tr_b16 v[140:141], v71 offset:8224
  ds_read_b64_tr_b16 v[142:143], v71 offset:8736
  ds_read_b64_tr_b16 v[144:145], v71 offset:8256
  ds_read_b64_tr_b16 v[146:147], v71 offset:8768
  ds_read_b64_tr_b16 v[148:149], v71 offset:8288
  ds_read_b64_tr_b16 v[150:151], v71 offset:8800
  s_waitcnt lgkmcnt(0)
  v_mfma_f32_16x16x32_bf16 v[168:171], v[16:19], v[136:139], v[168:171]
  v_mfma_f32_16x16x32_bf16 v[172:175], v[16:19], v[140:143], v[172:175]
  v_mfma_f32_16x16x32_bf16 v[176:179], v[16:19], v[144:147], v[176:179]
  v_mfma_f32_16x16x32_bf16 v[180:183], v[16:19], v[148:151], v[180:183]
  ds_read_b64_tr_b16 v[152:153], v71 offset:12288
  ds_read_b64_tr_b16 v[154:155], v71 offset:12800
  ds_read_b64_tr_b16 v[156:157], v71 offset:12320
  ds_read_b64_tr_b16 v[158:159], v71 offset:12832
  ds_read_b64_tr_b16 v[160:161], v71 offset:12352
  ds_read_b64_tr_b16 v[162:163], v71 offset:12864
  ds_read_b64_tr_b16 v[164:165], v71 offset:12384
  ds_read_b64_tr_b16 v[166:167], v71 offset:12896
  s_waitcnt lgkmcnt(0)
  v_mfma_f32_16x16x32_bf16 v[168:171], v[20:23], v[152:155], v[168:171]
  v_mfma_f32_16x16x32_bf16 v[172:175], v[20:23], v[156:159], v[172:175]
  v_mfma_f32_16x16x32_bf16 v[176:179], v[20:23], v[160:163], v[176:179]
  v_mfma_f32_16x16x32_bf16 v[180:183], v[20:23], v[164:167], v[180:183]
  ds_read_b64_tr_b16 v[136:137], v71 offset:16384
  ds_read_b64_tr_b16 v[138:139], v71 offset:16896
  ds_read_b64_tr_b16 v[140:141], v71 offset:16416
  ds_read_b64_tr_b16 v[142:143], v71 offset:16928
  ds_read_b64_tr_b16 v[144:145], v71 offset:16448
  ds_read_b64_tr_b16 v[146:147], v71 offset:16960
  ds_read_b64_tr_b16 v[148:149], v71 offset:16480
  ds_read_b64_tr_b16 v[150:151], v71 offset:16992
  s_waitcnt lgkmcnt(0)
  v_mfma_f32_16x16x32_bf16 v[168:171], v[24:27], v[136:139], v[168:171]
  v_mfma_f32_16x16x32_bf16 v[172:175], v[24:27], v[140:143], v[172:175]
  v_mfma_f32_16x16x32_bf16 v[176:179], v[24:27], v[144:147], v[176:179]
  v_mfma_f32_16x16x32_bf16 v[180:183], v[24:27], v[148:151], v[180:183]
  ds_read_b64_tr_b16 v[152:153], v71 offset:20480
  ds_read_b64_tr_b16 v[154:155], v71 offset:20992
  ds_read_b64_tr_b16 v[156:157], v71 offset:20512
  ds_read_b64_tr_b16 v[158:159], v71 offset:21024
  ds_read_b64_tr_b16 v[160:161], v71 offset:20544
  ds_read_b64_tr_b16 v[162:163], v71 offset:21056
  ds_read_b64_tr_b16 v[164:165], v71 offset:20576
  ds_read_b64_tr_b16 v[166:167], v71 offset:21088
  s_waitcnt lgkmcnt(0)
  v_mfma_f32_16x16x32_bf16 v[168:171], v[28:31], v[152:155], v[168:171]
  v_mfma_f32_16x16x32_bf16 v[172:175], v[28:31], v[156:159], v[172:175]
  v_mfma_f32_16x16x32_bf16 v[176:179], v[28:31], v[160:163], v[176:179]
  v_mfma_f32_16x16x32_bf16 v[180:183], v[28:31], v[164:167], v[180:183]
  ds_read_b64_tr_b16 v[136:137], v71 offset:24576
  ds_read_b64_tr_b16 v[138:139], v71 offset:25088
  ds_read_b64_tr_b16 v[140:141], v71 offset:24608
  ds_read_b64_tr_b16 v[142:143], v71 offset:25120
  ds_read_b64_tr_b16 v[144:145], v71 offset:24640
  ds_read_b64_tr_b16 v[146:147], v71 offset:25152
  ds_read_b64_tr_b16 v[148:149], v71 offset:24672
  ds_read_b64_tr_b16 v[150:151], v71 offset:25184
  s_waitcnt lgkmcnt(0)
  v_mfma_f32_16x16x32_bf16 v[168:171], v[32:35], v[136:139], v[168:171]
  v_mfma_f32_16x16x32_bf16 v[172:175], v[32:35], v[140:143], v[172:175]
  v_mfma_f32_16x16x32_bf16 v[176:179], v[32:35], v[144:147], v[176:179]
  v_mfma_f32_16x16x32_bf16 v[180:183], v[32:35], v[148:151], v[180:183]
  ds_read_b64_tr_b16 v[152:153], v71 offset:28672
  ds_read_b64_tr_b16 v[154:155], v71 offset:29184
  ds_read_b64_tr_b16 v[156:157], v71 offset:28704
  ds_read_b64_tr_b16 v[158:159], v71 offset:29216
  ds_read_b64_tr_b16 v[160:161], v71 offset:28736
  ds_read_b64_tr_b16 v[162:163], v71 offset:29248
  ds_read_b64_tr_b16 v[164:165], v71 offset:28768
  ds_read_b64_tr_b16 v[166:167], v71 offset:29280
  s_waitcnt lgkmcnt(0)
  v_mfma_f32_16x16x32_bf16 v[168:171], v[36:39], v[152:155], v[168:171]
  v_mfma_f32_16x16x32_bf16 v[172:175], v[36:39], v[156:159], v[172:175]
  v_mfma_f32_16x16x32_bf16 v[176:179], v[36:39], v[160:163], v[176:179]
  v_mfma_f32_16x16x32_bf16 v[180:183], v[36:39], v[164:167], v[180:183]
  ds_read_b64_tr_b16 v[136:137], v71 offset:32768
  ds_read_b64_tr_b16 v[138:139], v71 offset:33280
  ds_read_b64_tr_b16 v[140:141], v71 offset:32800
  ds_read_b64_tr_b16 v[142:143], v71 offset:33312
  ds_read_b64_tr_b16 v[144:145], v71 offset:32832
  ds_read_b64_tr_b16 v[146:147], v71 offset:33344
  ds_read_b64_tr_b16 v[148:149], v71 offset:32864
  ds_read_b64_tr_b16 v[150:151], v71 offset:33376
  s_waitcnt lgkmcnt(0)
  v_mfma_f32_16x16x32_bf16 v[168:171], v[40:43], v[136:139], v[168:171]
  v_mfma_f32_16x16x32_bf16 v[172:175], v[40:43], v[140:143], v[172:175]
  v_mfma_f32_16x16x32_bf16 v[176:179], v[40:43], v[144:147], v[176:179]
  v_mfma_f32_16x16x32_bf16 v[180:183], v[40:43], v[148:151], v[180:183]
  ds_read_b64_tr_b16 v[152:153], v71 offset:36864
  ds_read_b64_tr_b16 v[154:155], v71 offset:37376
  ds_read_b64_tr_b16 v[156:157], v71 offset:36896
  ds_read_b64_tr_b16 v[158:159], v71 offset:37408
  ds_read_b64_tr_b16 v[160:161], v71 offset:36928
  ds_read_b64_tr_b16 v[162:163], v71 offset:37440
  ds_read_b64_tr_b16 v[164:165], v71 offset:36960
  ds_read_b64_tr_b16 v[166:167], v71 offset:37472
  s_waitcnt lgkmcnt(0)
  v_mfma_f32_16x16x32_bf16 v[168:171], v[44:47], v[152:155], v[168:171]
  v_mfma_f32_16x16x32_bf16 v[172:175], v[44:47], v[156:159], v[172:175]
  v_mfma_f32_16x16x32_bf16 v[176:179], v[44:47], v[160:163], v[176:179]
  v_mfma_f32_16x16x32_bf16 v[180:183], v[44:47], v[164:167], v[180:183]
  ds_read_b64_tr_b16 v[136:137], v71 offset:40960
  ds_read_b64_tr_b16 v[138:139], v71 offset:41472
  ds_read_b64_tr_b16 v[140:141], v71 offset:40992
  ds_read_b64_tr_b16 v[142:143], v71 offset:41504
  ds_read_b64_tr_b16 v[144:145], v71 offset:41024
  ds_read_b64_tr_b16 v[146:147], v71 offset:41536
  ds_read_b64_tr_b16 v[148:149], v71 offset:41056
  ds_read_b64_tr_b16 v[150:151], v71 offset:41568
  s_waitcnt lgkmcnt(0)
  v_mfma_f32_16x16x32_bf16 v[168:171], v[48:51], v[136:139], v[168:171]
  v_mfma_f32_16x16x32_bf16 v[172:175], v[48:51], v[140:143], v[172:175]
  v_mfma_f32_16x16x32_bf16 v[176:179], v[48:51], v[144:147], v[176:179]
  v_mfma_f32_16x16x32_bf16 v[180:183], v[48:51], v[148:151], v[180:183]
  ds_read_b64_tr_b16 v[152:153], v71 offset:45056
  ds_read_b64_tr_b16 v[154:155], v71 offset:45568
  ds_read_b64_tr_b16 v[156:157], v71 offset:45088
  ds_read_b64_tr_b16 v[158:159], v71 offset:45600
  ds_read_b64_tr_b16 v[160:161], v71 offset:45120
  ds_read_b64_tr_b16 v[162:163], v71 offset:45632
  ds_read_b64_tr_b16 v[164:165], v71 offset:45152
  ds_read_b64_tr_b16 v[166:167], v71 offset:45664
  s_waitcnt lgkmcnt(0)
  v_mfma_f32_16x16x32_bf16 v[168:171], v[52:55], v[152:155], v[168:171]
  v_mfma_f32_16x16x32_bf16 v[172:175], v[52:55], v[156:159], v[172:175]
  v_mfma_f32_16x16x32_bf16 v[176:179], v[52:55], v[160:163], v[176:179]
  v_mfma_f32_16x16x32_bf16 v[180:183], v[52:55], v[164:167], v[180:183]
  ds_read_b64_tr_b16 v[136:137], v71 offset:49152
  ds_read_b64_tr_b16 v[138:139], v71 offset:49664
  ds_read_b64_tr_b16 v[140:141], v71 offset:49184
  ds_read_b64_tr_b16 v[142:143], v71 offset:49696
  ds_read_b64_tr_b16 v[144:145], v71 offset:49216
  ds_read_b64_tr_b16 v[146:147], v71 offset:49728
  ds_read_b64_tr_b16 v[148:149], v71 offset:49248
  ds_read_b64_tr_b16 v[150:151], v71 offset:49760
  s_waitcnt lgkmcnt(0)
  v_mfma_f32_16x16x32_bf16 v[168:171], v[56:59], v[136:139], v[168:171]
  v_mfma_f32_16x16x32_bf16 v[172:175], v[56:59], v[140:143], v[172:175]
  v_mfma_f32_16x16x32_bf16 v[176:179], v[56:59], v[144:147], v[176:179]
  v_mfma_f32_16x16x32_bf16 v[180:183], v[56:59], v[148:151], v[180:183]
  ds_read_b64_tr_b16 v[152:153], v71 offset:53248
  ds_read_b64_tr_b16 v[154:155], v71 offset:53760
  ds_read_b64_tr_b16 v[156:157], v71 offset:53280
  ds_read_b64_tr_b16 v[158:159], v71 offset:53792
  ds_read_b64_tr_b16 v[160:161], v71 offset:53312
  ds_read_b64_tr_b16 v[162:163], v71 offset:53824
  ds_read_b64_tr_b16 v[164:165], v71 offset:53344
  ds_read_b64_tr_b16 v[166:167], v71 offset:53856
  s_waitcnt lgkmcnt(0)
  v_mfma_f32_16x16x32_bf16 v[168:171], v[60:63], v[152:155], v[168:171]
  v_mfma_f32_16x16x32_bf16 v[172:175], v[60:63], v[156:159], v[172:175]
  v_mfma_f32_16x16x32_bf16 v[176:179], v[60:63], v[160:163], v[176:179]
  v_mfma_f32_16x16x32_bf16 v[180:183], v[60:63], v[164:167], v[180:183]
  s_nop 7
  v_cndmask_b32 v112, v112, v168, s[54:55]
  v_cndmask_b32 v113, v113, v169, s[54:55]
  v_cndmask_b32 v114, v114, v170, s[54:55]
  v_cndmask_b32 v115, v115, v171, s[54:55]
  v_cndmask_b32 v116, v116, v172, s[54:55]
  v_cndmask_b32 v117, v117, v173, s[54:55]
  v_cndmask_b32 v118, v118, v174, s[54:55]
  v_cndmask_b32 v119, v119, v175, s[54:55]
  v_cndmask_b32 v120, v120, v176, s[54:55]
  v_cndmask_b32 v121, v121, v177, s[54:55]
  v_cndmask_b32 v122, v122, v178, s[54:55]
  v_cndmask_b32 v123, v123, v179, s[54:55]
  v_cndmask_b32 v124, v124, v180, s[54:55]
  v_cndmask_b32 v125, v125, v181, s[54:55]
  v_cndmask_b32 v126, v126, v182, s[54:55]
  v_cndmask_b32 v127, v127, v183, s[54:55]
  v_mov_b32 v168, v112
  v_mov_b32 v169, v113
  v_mov_b32 v170, v114
  v_mov_b32 v171, v115
  v_mov_b32 v172, v116
  v_mov_b32 v173, v117
  v_mov_b32 v174, v118
  v_mov_b32 v175, v119
  v_mov_b32 v176, v120
  v_mov_b32 v177, v121
  v_mov_b32 v178, v122
  v_mov_b32 v179, v123
  v_mov_b32 v180, v124
  v_mov_b32 v181, v125
  v_mov_b32 v182, v126
  v_mov_b32 v183, v127
  s_nop 1
  v_permlane32_swap_b32 v112, v168
  v_permlane32_swap_b32 v113, v169
  v_permlane32_swap_b32 v114, v170
  v_permlane32_swap_b32 v115, v171
  v_permlane32_swap_b32 v116, v172
  v_permlane32_swap_b32 v117, v173
  v_permlane32_swap_b32 v118, v174
  v_permlane32_swap_b32 v119, v175
  v_permlane32_swap_b32 v120, v176
  v_permlane32_swap_b32 v121, v177
  v_permlane32_swap_b32 v122, v178
  v_permlane32_swap_b32 v123, v179
  v_permlane32_swap_b32 v124, v180
  v_permlane32_swap_b32 v125, v181
  v_permlane32_swap_b32 v126, v182
  v_permlane32_swap_b32 v127, v183
  s_nop 0
  v_add_f32 v112, v112, v168
  v_add_f32 v113, v113, v169
  v_add_f32 v114, v114, v170
  v_add_f32 v115, v115, v171
  v_add_f32 v116, v116, v172
  v_add_f32 v117, v117, v173
  v_add_f32 v118, v118, v174
  v_add_f32 v119, v119, v175
  v_add_f32 v120, v120, v176
  v_add_f32 v121, v121, v177
  v_add_f32 v122, v122, v178
  v_add_f32 v123, v123, v179
  v_add_f32 v124, v124, v180
  v_add_f32 v125, v125, v181
  v_add_f32 v126, v126, v182
  v_add_f32 v127, v127, v183
  v_and_b32 v6, 1, v5
  v_lshlrev_b32 v6, 2, v6
  v_and_b32 v7, 2, v5
  v_add_u32 v6, v6, v7
  v_lshlrev_b32 v6, 8, v6
  v_lshl_add_u32 v6, v4, 4, v6
  s_lshl_b32 s38, s38, 11
  s_add_u32 s38, s38, 196608
  v_cndmask_b32 v72, v112, v114, s[54:55]
  v_cndmask_b32 v73, v116, v118, s[54:55]
  v_cndmask_b32 v74, v120, v122, s[54:55]
  v_cndmask_b32 v75, v124, v126, s[54:55]
  buffer_store_dwordx4 v[72:75], v6, s[12:15], s38 offen offset:0 sc1
  v_cndmask_b32 v76, v113, v115, s[54:55]
  v_cndmask_b32 v77, v117, v119, s[54:55]
  v_cndmask_b32 v78, v121, v123, s[54:55]
  v_cndmask_b32 v79, v125, v127, s[54:55]
  buffer_store_dwordx4 v[76:79], v6, s[12:15], s38 offen offset:256 sc1
L_flag:
  s_waitcnt vmcnt(0)
  v_mov_b32 v6, s33
  s_mov_b64 exec, 1
  buffer_store_dword v6, v70, s[12:15], s59 offen sc1
  s_mov_b64 exec, -1
  s_branch L_noj3
L_nojob:
  s_waitcnt vmcnt(0) lgkmcnt(0)
  v_mov_b32 v6, 0
  v_mov_b32 v7, 1
  s_mov_b64 exec, 1
  ds_add_u32 v6, v7 offset:18956
  s_mov_b64 exec, -1
  s_cmp_lg_u32 s3, 0
  s_cbranch_scc1 L_wo
  v_mov_b32 v6, 0
L_lw_23:
  s_sleep 4
  ds_read_b32 v7, v6 offset:18956
  s_waitcnt lgkmcnt(0)
  v_readfirstlane_b32 s40, v7
  s_cmp_lt_u32 s40, 4
  s_cbranch_scc1 L_lw_23
L_noj3:
  s_mov_b32 s60, s68
  s_mov_b32 s61, s69
  s_mov_b32 s62, 256
  s_mov_b32 s63, 0x20000
  v_mov_b32 v6, 0
L_lw_24:
  s_sleep 16
  ds_read_b32 v7, v6 offset:18944
  s_waitcnt lgkmcnt(0)
  v_readfirstlane_b32 s40, v7
  s_cmp_lt_u32 s40, 231
  s_cbranch_scc1 L_lw_24
  v_mov_b32 v7, 1
  s_mov_b64 exec, 1
  buffer_atomic_add v7, v6, s[60:63], 0 offen offset:128 sc0 sc1
  s_waitcnt vmcnt(0)
  v_and_b32 v7, 0xff, v7
  v_add_u32 v31, 1, v7
  ds_write_b32 v6, v31 offset:18960
  s_mov_b64 exec, -1
  v_readfirstlane_b32 s77, v7
  s_waitcnt lgkmcnt(0)
  s_cmp_ge_u32 s77, 224
  s_cbranch_scc1 L_hend
  s_mul_i32 s39, s77, 9363
  s_lshr_b32 s39, s39, 16
  s_mul_i32 s40, s39, 7
  s_sub_u32 s38, s77, s40
  s_mul_i32 s42, s39, 114688
  s_lshl_b32 s40, s38, 7
  s_add_u32 s42, s42, s40
  v_and_b32 v7, 7, v1
  s_lshl_b32 s43, s38, 14
  s_lshl_b32 s40, s39, 7
  s_add_u32 s43, s43, s40
  s_add_u32 s43, s43, 655360
  s_lshr_b32 s38, s77, 1
  s_lshl_b32 s38, s38, 6
  s_and_b32 s40, s77, 1
  s_lshl_b32 s40, s40, 4
  s_add_u32 s38, s38, s40
  v_lshl_add_u32 v36, v7, 1, s38
  s_mov_b32 s44, s16
  s_mov_b32 s45, s17
  s_mov_b32 s46, 7168
  s_mov_b32 s47, 0x20000
  s_mov_b32 s48, s66
  s_mov_b32 s49, s67
  s_mov_b32 s50, 7168
  s_mov_b32 s51, 0x20000
  buffer_load_ushort v34, v36, s[44:47], 0 offen
  buffer_load_ushort v35, v36, s[44:47], 0 offen offset:32
  s_waitcnt vmcnt(0)
  v_mov_b32 v6, 0
L_lw_25:
  s_sleep 8
  ds_read_b32 v7, v6 offset:18964
  s_waitcnt lgkmcnt(0)
  v_readfirstlane_b32 s40, v7
  s_cmp_lt_u32 s40, 3
  s_cbranch_scc1 L_lw_25
  ds_read_b64_tr_b16 v[136:137], v65 offset:19456
  ds_read_b64_tr_b16 v[138:139], v65 offset:19968
  ds_read_b64_tr_b16 v[140:141], v65 offset:19488
  ds_read_b64_tr_b16 v[142:143], v65 offset:20000
  ds_read_b64_tr_b16 v[144:145], v65 offset:19520
  ds_read_b64_tr_b16 v[146:147], v65 offset:20032
  ds_read_b64_tr_b16 v[148:149], v65 offset:19552
  ds_read_b64_tr_b16 v[150:151], v65 offset:20064
  s_waitcnt lgkmcnt(0)
  ds_read_b64_tr_b16 v[152:153], v65 offset:23552
  ds_read_b64_tr_b16 v[154:155], v65 offset:24064
  ds_read_b64_tr_b16 v[156:157], v65 offset:23584
  ds_read_b64_tr_b16 v[158:159], v65 offset:24096
  ds_read_b64_tr_b16 v[160:161], v65 offset:23616
  ds_read_b64_tr_b16 v[162:163], v65 offset:24128
  ds_read_b64_tr_b16 v[164:165], v65 offset:23648
  ds_read_b64_tr_b16 v[166:167], v65 offset:24160
  s_waitcnt lgkmcnt(0)
  ds_read_b64_tr_b16 v[168:169], v65 offset:27648
  ds_read_b64_tr_b16 v[170:171], v65 offset:28160
  ds_read_b64_tr_b16 v[172:173], v65 offset:27680
  ds_read_b64_tr_b16 v[174:175], v65 offset:28192
  ds_read_b64_tr_b16 v[176:177], v65 offset:27712
  ds_read_b64_tr_b16 v[178:179], v65 offset:28224
  ds_read_b64_tr_b16 v[180:181], v65 offset:27744
  ds_read_b64_tr_b16 v[182:183], v65 offset:28256
  s_waitcnt lgkmcnt(0)
  ds_read_b64_tr_b16 v[184:185], v65 offset:31744
  ds_read_b64_tr_b16 v[186:187], v65 offset:32256
  ds_read_b64_tr_b16 v[188:189], v65 offset:31776
  ds_read_b64_tr_b16 v[190:191], v65 offset:32288
  ds_read_b64_tr_b16 v[192:193], v65 offset:31808
  ds_read_b64_tr_b16 v[194:195], v65 offset:32320
  ds_read_b64_tr_b16 v[196:197], v65 offset:31840
  ds_read_b64_tr_b16 v[198:199], v65 offset:32352
  s_waitcnt lgkmcnt(0)
  v_and_b32 v6, 1, v5
  v_mul_u32_u24 v6, 112, v6
  v_and_b32 v7, 2, v5
  v_add_u32 v6, v6, v7
  v_lshrrev_b32 v7, 3, v4
  v_add_u32 v6, v6, v7
  v_mul_u32_u24 v6, 4096, v6
  v_and_b32 v7, 7, v4
  v_lshl_add_u32 v6, v7, 4, v6
  v_lshlrev_b32 v34, 16, v34
  v_lshlrev_b32 v35, 16, v35
  v_mul_u32_u24 v38, 272, v7
  v_lshl_add_u32 v38, v5, 4, v38
  s_mul_i32 s38, s77, 2341
  s_lshr_b32 s38, s38, 16
  s_mul_i32 s39, s38, 28
  s_sub_u32 s39, s77, s39
  s_lshr_b32 s40, s39, 2
  s_lshl_b32 s52, s40, 7
  s_add_u32 s52, s52, 167424
  s_lshl_b32 s40, s40, 11
  s_lshl_b32 s38, s38, 8
  s_add_u32 s38, s38, s40
  s_and_b32 s40, s39, 1
  s_lshl_b32 s40, s40, 7
  s_add_u32 s38, s38, s40
  s_and_b32 s40, s39, 2
  s_lshl_b32 s40, s40, 2
  s_add_u32 s38, s38, s40
  s_add_u32 s38, s38, 196608
  v_bfe_u32 v39, v1, 3, 1
  v_mul_u32_u24 v37, 896, v39
  v_mul_u32_u24 v39, 14336, v39
  v_lshl_add_u32 v39, v7, 4, v39
  v_mov_b32 v31, v6
  v_mov_b32 v6, 0
L_lw_26:
  s_sleep 16
  ds_read_b32 v7, v6 offset:18944
  s_waitcnt lgkmcnt(0)
  v_readfirstlane_b32 s40, v7
  s_cmp_lt_u32 s40, 245
  s_cbranch_scc1 L_lw_26
  v_mov_b32 v6, v31
  s_mov_b32 s41, 20000
L_y_27:
  buffer_load_dword v72, v37, s[12:15], s52 offen sc1
  s_waitcnt vmcnt(0)
  v_xor_b32 v104, s33, v72
  v_cmp_ne_u32 vcc, 0, v104
  s_nop 4
  s_cbranch_vccz L_dn_28
  s_sub_u32 s41, s41, 1
  s_cmp_eq_u32 s41, 0
  s_cbranch_scc1 L_dn_28
  s_sleep 24
  s_branch L_y_27
L_dn_28:
  buffer_load_dwordx2 v[32:33], v39, s[12:15], s38 offen sc1
  s_waitcnt vmcnt(0)
  v_add_f32_dpp v32, v32, v32 row_ror:8 row_mask:0xf bank_mask:0xf
  v_add_f32_dpp v33, v33, v33 row_ror:8 row_mask:0xf bank_mask:0xf
  v_cvt_pk_bf16_f32 v33, v32, v33
  v_lshlrev_b32 v32, 16, v33
  v_and_b32 v33, 0xffff0000, v33
  v_mul_f32 v104, 0xbfb8aa3b, v32
  v_exp_f32 v104, v104
  s_nop 0
  v_add_f32 v104, 1.0, v104
  v_rcp_f32 v104, v104
  s_nop 0
  v_mul_f32 v32, v32, v104
  v_mul_f32 v104, 0xbfb8aa3b, v33
  v_exp_f32 v104, v104
  s_nop 0
  v_add_f32 v104, 1.0, v104
  v_rcp_f32 v104, v104
  s_nop 0
  v_mul_f32 v33, v33, v104
  v_cvt_pk_bf16_f32 v33, v32, v33
  v_lshlrev_b32 v32, 16, v33
  v_and_b32 v33, 0xffff0000, v33
  s_lshl_b32 s38, s77, 12
  s_add_u32 s38, s38, 655360
  s_barrier
  s_barrier
  ds_read_b128 v[8:11], v38 offset:16704
  ds_read_b128 v[12:15], v38 offset:16768
  ds_read_b128 v[16:19], v38 offset:16832
  ds_read_b128 v[20:23], v38 offset:16896
  s_waitcnt lgkmcnt(0)
  v_mfma_f32_16x16x32_bf16 v[112:115], v[8:11], v[136:139], 0
  v_mfma_f32_16x16x32_bf16 v[116:119], v[8:11], v[140:143], 0
  v_mfma_f32_16x16x32_bf16 v[120:123], v[8:11], v[144:147], 0
  v_mfma_f32_16x16x32_bf16 v[124:127], v[8:11], v[148:151], 0
  v_mfma_f32_16x16x32_bf16 v[112:115], v[12:15], v[152:155], v[112:115]
  v_mfma_f32_16x16x32_bf16 v[116:119], v[12:15], v[156:159], v[116:119]
  v_mfma_f32_16x16x32_bf16 v[120:123], v[12:15], v[160:163], v[120:123]
  v_mfma_f32_16x16x32_bf16 v[124:127], v[12:15], v[164:167], v[124:127]
  v_mfma_f32_16x16x32_bf16 v[112:115], v[16:19], v[168:171], v[112:115]
  v_mfma_f32_16x16x32_bf16 v[116:119], v[16:19], v[172:175], v[116:119]
  v_mfma_f32_16x16x32_bf16 v[120:123], v[16:19], v[176:179], v[120:123]
  v_mfma_f32_16x16x32_bf16 v[124:127], v[16:19], v[180:183], v[124:127]
  v_mfma_f32_16x16x32_bf16 v[112:115], v[20:23], v[184:187], v[112:115]
  v_mfma_f32_16x16x32_bf16 v[116:119], v[20:23], v[188:191], v[116:119]
  v_mfma_f32_16x16x32_bf16 v[120:123], v[20:23], v[192:195], v[120:123]
  v_mfma_f32_16x16x32_bf16 v[124:127], v[20:23], v[196:199], v[124:127]
  v_mov_b32 v73, s33
  v_mov_b32 v75, s33
  v_mov_b32 v77, s33
  v_mov_b32 v79, s33
  v_mov_b32 v81, s33
  v_mov_b32 v83, s33
  v_mov_b32 v85, s33
  v_mov_b32 v87, s33
  v_cndmask_b32 v72, v112, v120, s[54:55]
  v_cndmask_b32 v74, v116, v124, s[54:55]
  s_add_u32 s40, s43, 0
  buffer_store_dwordx4 v[72:75], v6, s[12:15], s40 offen sc1
  v_cndmask_b32 v76, v113, v121, s[54:55]
  v_cndmask_b32 v78, v117, v125, s[54:55]
  s_add_u32 s40, s43, 114688
  buffer_store_dwordx4 v[76:79], v6, s[12:15], s40 offen sc1
  v_cndmask_b32 v80, v114, v122, s[54:55]
  v_cndmask_b32 v82, v118, v126, s[54:55]
  s_add_u32 s40, s43, 229376
  buffer_store_dwordx4 v[80:83], v6, s[12:15], s40 offen sc1
  v_cndmask_b32 v84, v115, v123, s[54:55]
  v_cndmask_b32 v86, v119, v127, s[54:55]
  s_add_u32 s40, s43, 344064
  buffer_store_dwordx4 v[84:87], v6, s[12:15], s40 offen sc1
  s_mov_b32 s41, 20000
L_sp:
  buffer_load_dwordx4 v[136:139], v70, s[12:15], s38 offen offset:0 sc1
  buffer_load_dwordx4 v[140:143], v70, s[12:15], s38 offen offset:1024 sc1
  buffer_load_dwordx4 v[144:147], v70, s[12:15], s38 offen offset:2048 sc1
  buffer_load_dwordx4 v[148:151], v70, s[12:15], s38 offen offset:3072 sc1
  s_waitcnt vmcnt(0)
  v_xor_b32 v88, s33, v137
  v_xor_b32 v89, s33, v139
  v_xor_b32 v90, s33, v141
  v_xor_b32 v91, s33, v143
  v_xor_b32 v92, s33, v145
  v_xor_b32 v93, s33, v147
  v_xor_b32 v94, s33, v149
  v_xor_b32 v95, s33, v151
  v_or3_b32 v88, v88, v89, v90
  v_or3_b32 v91, v91, v92, v93
  v_or3_b32 v88, v88, v94, v95
  v_or_b32 v88, v88, v91
  v_cmp_ne_u32 vcc, 0, v88
  v_add_f32 v28, v136, v140
  v_add_f32 v29, v138, v142
  v_add_f32 v30, v144, v148
  v_add_f32 v31, v146, v150
  v_add_f32 v30, v28, v30
  v_add_f32 v31, v29, v31
  s_cbranch_vccz L_sok
  s_sub_u32 s41, s41, 1
  s_cbranch_scc0 L_sp
L_sok:
  s_nop 0
  v_add_f32_dpp v30, v30, v30 row_ror:8 row_mask:0xf bank_mask:0xf
  v_add_f32_dpp v31, v31, v31 row_ror:8 row_mask:0xf bank_mask:0xf
  v_mov_b32 v104, v30
  v_mov_b32 v105, v31
  s_nop 0
  v_permlane16_swap_b32 v30, v104
  v_permlane16_swap_b32 v31, v105
  v_add_f32 v30, v30, v104
  v_add_f32 v31, v31, v105
  v_mov_b32 v104, v30
  v_mov_b32 v105, v31
  s_nop 0
  v_permlane32_swap_b32 v30, v104
  v_permlane32_swap_b32 v31, v105
  v_add_f32 v30, v30, v104
  v_add_f32 v31, v31, v105
  v_cvt_pk_bf16_f32 v31, v30, v31
  v_lshlrev_b32 v30, 16, v31
  v_and_b32 v31, 0xffff0000, v31
  v_mul_f32 v30, v30, v32
  v_mul_f32 v31, v31, v33
  v_cvt_pk_bf16_f32 v31, v30, v31
  v_lshlrev_b32 v30, 16, v31
  v_and_b32 v31, 0xffff0000, v31
  v_add_f32 v30, v30, v34
  v_add_f32 v31, v31, v35
  v_cvt_pk_bf16_f32 v31, v30, v31
  s_mov_b64 exec, 0xff
  buffer_store_short v31, v36, s[48:51], 0 offen
  buffer_store_short_d16_hi v31, v36, s[48:51], 0 offen offset:32
  s_cmp_lg_u32 s77, 0
  s_cbranch_scc1 L_hend
  s_mov_b64 exec, 1
  v_mov_b32 v30, s33
  buffer_store_dword v30, v70, s[12:15], 0 offen sc1
L_hend:
  s_endpgm
L_wo:
  v_mov_b32 v6, 0
L_lw_29:
  s_sleep 16
  ds_read_b32 v7, v6 offset:18960
  s_waitcnt lgkmcnt(0)
  v_readfirstlane_b32 s40, v7
  s_cmp_eq_u32 s40, 0
  s_cbranch_scc1 L_lw_29
  s_sub_u32 s77, s40, 1
  s_cmp_ge_u32 s77, 224
  s_cbranch_scc1 L_exit
  s_mul_i32 s39, s77, 9363
  s_lshr_b32 s39, s39, 16
  s_mul_i32 s40, s39, 7
  s_sub_u32 s38, s77, s40
  s_mul_i32 s42, s39, 114688
  s_lshl_b32 s40, s38, 7
  s_add_u32 s42, s42, s40
  v_lshrrev_b32 v2, 4, v1
  v_bfe_u32 v7, v1, 3, 1
  v_lshl_add_u32 v2, v2, 3, v7
  v_mul_u32_u24 v2, 896, v2
  v_and_b32 v7, 7, v1
  v_lshl_add_u32 v2, v7, 4, v2
  s_mov_b32 s8, s24
  s_mov_b32 s9, s25
  s_mov_b32 s10, 3670016
  s_mov_b32 s11, 0x20000
  s_cmp_lg_u32 s3, 1
  s_cbranch_scc1 L_wo_30
  s_mov_b32 m0, 19456
  s_mov_b32 s40, -57344
  s_bitcmp1_b32 s39, 0
  s_cselect_b32 s40, s40, 0
  s_add_u32 s40, s40, s42
  buffer_load_dwordx4 v2, s[8:11], s40 offen nt lds
L_wo_30:
  s_cmp_lg_u32 s3, 2
  s_cbranch_scc1 L_wo_31
  s_mov_b32 m0, 20480
  s_mov_b32 s40, -28672
  s_bitcmp1_b32 s39, 0
  s_cselect_b32 s40, s40, 28672
  s_add_u32 s40, s40, s42
  buffer_load_dwordx4 v2, s[8:11], s40 offen nt lds
L_wo_31:
  s_cmp_lg_u32 s3, 3
  s_cbranch_scc1 L_wo_32
  s_mov_b32 m0, 21504
  s_mov_b32 s40, 28672
  s_bitcmp1_b32 s39, 0
  s_cselect_b32 s40, s40, 114688
  s_add_u32 s40, s40, s42
  buffer_load_dwordx4 v2, s[8:11], s40 offen nt lds
L_wo_32:
  s_cmp_lg_u32 s3, 1
  s_cbranch_scc1 L_wo_33
  s_mov_b32 m0, 22528
  s_mov_b32 s40, 86016
  s_bitcmp1_b32 s39, 0
  s_cselect_b32 s40, s40, 172032
  s_add_u32 s40, s40, s42
  buffer_load_dwordx4 v2, s[8:11], s40 offen nt lds
L_wo_33:
  s_cmp_lg_u32 s3, 2
  s_cbranch_scc1 L_wo_34
  s_mov_b32 m0, 23552
  s_mov_b32 s40, -55552
  s_bitcmp1_b32 s39, 0
  s_cselect_b32 s40, s40, 1792
  s_add_u32 s40, s40, s42
  buffer_load_dwordx4 v2, s[8:11], s40 offen nt lds
L_wo_34:
  s_cmp_lg_u32 s3, 3
  s_cbranch_scc1 L_wo_35
  s_mov_b32 m0, 24576
  s_mov_b32 s40, -26880
  s_bitcmp1_b32 s39, 0
  s_cselect_b32 s40, s40, 30464
  s_add_u32 s40, s40, s42
  buffer_load_dwordx4 v2, s[8:11], s40 offen nt lds
L_wo_35:
  s_cmp_lg_u32 s3, 1
  s_cbranch_scc1 L_wo_36
  s_mov_b32 m0, 25600
  s_mov_b32 s40, 30464
  s_bitcmp1_b32 s39, 0
  s_cselect_b32 s40, s40, 116480
  s_add_u32 s40, s40, s42
  buffer_load_dwordx4 v2, s[8:11], s40 offen nt lds
L_wo_36:
  s_cmp_lg_u32 s3, 2
  s_cbranch_scc1 L_wo_37
  s_mov_b32 m0, 26624
  s_mov_b32 s40, 87808
  s_bitcmp1_b32 s39, 0
  s_cselect_b32 s40, s40, 173824
  s_add_u32 s40, s40, s42
  buffer_load_dwordx4 v2, s[8:11], s40 offen nt lds
L_wo_37:
  s_cmp_lg_u32 s3, 3
  s_cbranch_scc1 L_wo_38
  s_mov_b32 m0, 27648
  s_mov_b32 s40, -53760
  s_bitcmp1_b32 s39, 0
  s_cselect_b32 s40, s40, 3584
  s_add_u32 s40, s40, s42
  buffer_load_dwordx4 v2, s[8:11], s40 offen nt lds
L_wo_38:
  s_cmp_lg_u32 s3, 1
  s_cbranch_scc1 L_wo_39
  s_mov_b32 m0, 28672
  s_mov_b32 s40, -25088
  s_bitcmp1_b32 s39, 0
  s_cselect_b32 s40, s40, 32256
  s_add_u32 s40, s40, s42
  buffer_load_dwordx4 v2, s[8:11], s40 offen nt lds
L_wo_39:
  s_cmp_lg_u32 s3, 2
  s_cbranch_scc1 L_wo_40
  s_mov_b32 m0, 29696
  s_mov_b32 s40, 32256
  s_bitcmp1_b32 s39, 0
  s_cselect_b32 s40, s40, 118272
  s_add_u32 s40, s40, s42
  buffer_load_dwordx4 v2, s[8:11], s40 offen nt lds
L_wo_40:
  s_cmp_lg_u32 s3, 3
  s_cbranch_scc1 L_wo_41
  s_mov_b32 m0, 30720
  s_mov_b32 s40, 89600
  s_bitcmp1_b32 s39, 0
  s_cselect_b32 s40, s40, 175616
  s_add_u32 s40, s40, s42
  buffer_load_dwordx4 v2, s[8:11], s40 offen nt lds
L_wo_41:
  s_cmp_lg_u32 s3, 1
  s_cbranch_scc1 L_wo_42
  s_mov_b32 m0, 31744
  s_mov_b32 s40, -51968
  s_bitcmp1_b32 s39, 0
  s_cselect_b32 s40, s40, 5376
  s_add_u32 s40, s40, s42
  buffer_load_dwordx4 v2, s[8:11], s40 offen nt lds
L_wo_42:
  s_cmp_lg_u32 s3, 2
  s_cbranch_scc1 L_wo_43
  s_mov_b32 m0, 32768
  s_mov_b32 s40, -23296
  s_bitcmp1_b32 s39, 0
  s_cselect_b32 s40, s40, 34048
  s_add_u32 s40, s40, s42
  buffer_load_dwordx4 v2, s[8:11], s40 offen nt lds
L_wo_43:
  s_cmp_lg_u32 s3, 3
  s_cbranch_scc1 L_wo_44
  s_mov_b32 m0, 33792
  s_mov_b32 s40, 34048
  s_bitcmp1_b32 s39, 0
  s_cselect_b32 s40, s40, 120064
  s_add_u32 s40, s40, s42
  buffer_load_dwordx4 v2, s[8:11], s40 offen nt lds
L_wo_44:
  s_cmp_lg_u32 s3, 1
  s_cbranch_scc1 L_wo_45
  s_mov_b32 m0, 34816
  s_mov_b32 s40, 91392
  s_bitcmp1_b32 s39, 0
  s_cselect_b32 s40, s40, 177408
  s_add_u32 s40, s40, s42
  buffer_load_dwordx4 v2, s[8:11], s40 offen nt lds
L_wo_45:
  s_waitcnt vmcnt(0) lgkmcnt(0)
  v_mov_b32 v6, 0
  v_mov_b32 v7, 1
  s_mov_b64 exec, 1
  ds_add_u32 v6, v7 offset:18964
  s_mov_b64 exec, -1
  s_waitcnt lgkmcnt(0)
  s_endpgm
L_exit:
  s_endpgm
.section .rodata,"a"
.p2align 6
.amdhsa_kernel recurrent_scan__gqa_block_cached__glu_gated_bilinear__decode_kernel
  .amdhsa_next_free_vgpr 232
  .amdhsa_next_free_sgpr 102
  .amdhsa_accum_offset 232
  .amdhsa_group_segment_fixed_size 0
  .amdhsa_kernarg_size 96
  .amdhsa_user_sgpr_count 2
  .amdhsa_user_sgpr_kernarg_segment_ptr 1
  .amdhsa_system_sgpr_workgroup_id_x 1
.end_amdhsa_kernel
```
